```python
import torch

def _softmax(x, axis=-1):
    return torch.softmax(x, dim=axis)
def _gelu(x):
    return torch.nn.functional.gelu(x, approximate="tanh")
def _silu(x):
    return torch.nn.functional.silu(x)
def _sigmoid(x):
    return torch.sigmoid(x)
def _layernorm(x, axis=-1, eps=1e-5):
    m = x.mean(dim=axis, keepdim=True)
    v = x.var(dim=axis, keepdim=True, unbiased=False)
    return (x - m) / torch.sqrt(v + eps)
def _scatter_add(tgt, idx, src, axis=0):
    return tgt.clone().index_add_(axis, idx, src)
def _segment_sum(src, seg, n):
    out = torch.zeros((n,) + src.shape[1:], dtype=src.dtype)
    return out.index_add_(0, seg, src)
def _pad(x, pw):
    flat = tuple(v for pair in reversed(pw) for v in pair)
    return torch.nn.functional.pad(x, flat)

kernel_name = 'standalone__gqa_block_cached__sampling'

def setup_inputs():

    _w = (lambda a: (lambda t: t.to(torch.bfloat16) if t.is_floating_point() else t)(torch.as_tensor(a)))
    B, Sq, D = 32, 4, 1024
    Hq, Hkv, Sk, Dh = 32, 4, 2048, 128
    assert Hq % Hkv == 0, (Hq, Hkv)
    return {
        "x": _w((lambda *s: torch.randn(*s, dtype=torch.bfloat16) * 0.8)(B, Sq, D)),
        "k_cache": _w((lambda *s: torch.randn(*s, dtype=torch.bfloat16) * 0.8)(B, Hkv, Sk, Dh)),
        "v_cache": _w((lambda *s: torch.randn(*s, dtype=torch.bfloat16) * 0.05)(B, Hkv, Sk, Dh)),
        "wq": _w((lambda *s: torch.randn(*s, dtype=torch.bfloat16) * 0.8)(D, Hq * Dh) * (D ** -0.5)),
        "wo": _w((lambda *s: torch.randn(*s, dtype=torch.bfloat16) * 0.05)(Hq * Dh, D) * ((Hq * Dh) ** -0.5)),
    }

def reference(x, k_cache, v_cache, wq, wo):
    B, Sq, D = x.shape
    Hq, Dh = 32, 128
    Hkv = k_cache.shape[1]
    rep = Hq // Hkv
    q = (lambda x, *d: x.permute(*d))((x @ wq).reshape(B, Sq, Hq, Dh), 0, 2, 1, 3)
    k = (lambda x, n, axis: torch.repeat_interleave(x, n, dim=axis))(k_cache, rep, axis=1)
    v = (lambda x, n, axis: torch.repeat_interleave(x, n, dim=axis))(v_cache, rep, axis=1)
    scores = torch.einsum("bhqd,bhkd->bhqk", q, k) * (Dh ** -0.5)
    p = _softmax(scores, axis=-1)
    o = torch.einsum("bhqk,bhkd->bhqd", p, v)
    return (lambda x, *d: x.permute(*d))(o, 0, 2, 1, 3).reshape(B, Sq, Hq * Dh) @ wo
```

```asm
; @launch grid=(256,1,1) block=(512,1,1) lds=163840
.amdgcn_target "amdgcn-amd-amdhsa--gfx950"
.text
.globl standalone__gqa_block_cached__sampling_kernel
.p2align 8
.type standalone__gqa_block_cached__sampling_kernel,@function
standalone__gqa_block_cached__sampling_kernel:
    s_cmp_ge_u32 s2, 256
    s_cbranch_scc1 L_exit
    s_load_dwordx16 s[4:19], s[0:1], 0
    v_and_b32 v1, 63, v0
    v_lshrrev_b32 v4, 6, v0
    v_lshlrev_b32 v2, 4, v1
    v_readfirstlane_b32 s40, v4
    s_and_b32 s48, s2, 7
    s_lshr_b32 s49, s2, 3
    v_mov_b32 v3, 0x26000
    v_mov_b32 v14, 1
    s_cmp_lg_u32 s40, 7
    s_cbranch_scc1 L_p1
    s_getpc_b64 s[96:97]
    s_and_b32 s96, s96, 0xffffff00
    s_min_u32 s43, s49, 20
    s_lshl_b32 s43, s43, 10
    v_add_u32 v5, s43, v2
    global_load_dwordx4 v[64:67], v5, s[96:97]
    v_mov_b32 v4, 0
    v_lshl_add_u32 v5, v1, 2, v3
    ds_write_b32 v5, v4
L_p1:
    s_lshl_b32 s43, s48, 4
    s_and_b32 s44, s49, 15
    s_add_u32 s43, s43, s44
    s_lshl_b32 s50, s43, 1
    s_lshr_b32 s44, s49, 4
    s_add_u32 s50, s50, s44
    s_lshl_b32 s47, s50, 18
    s_mul_i32 s43, s2, 0x9e3779b1
    s_lshr_b32 s43, s43, 20
    s_add_u32 s43, s43, s40
    s_and_b32 s43, s43, 7
    s_lshl_b32 s43, s43, 15
    s_add_u32 s47, s47, s43
    s_mov_b32 s42, 131072
    s_mov_b32 s26, 0x4000000
    s_mov_b32 s27, 0x20000
    s_mov_b32 s22, 0x4000000
    s_mov_b32 s23, 0x20000
    s_mov_b32 s30, 0x10000000
    s_mov_b32 s31, 0x20000
    s_mov_b32 s34, 0x40000
    s_mov_b32 s35, 0x20000
    s_mov_b32 s38, 0x800000
    s_mov_b32 s39, 0x20000
    s_waitcnt lgkmcnt(0)
    s_load_dword s41, s[18:19], 0
    s_mov_b32 s24, s8
    s_and_b32 s25, s9, 0xffff
    s_mov_b32 s20, s6
    s_and_b32 s21, s7, 0xffff
    s_mov_b32 s28, s18
    s_and_b32 s29, s19, 0xffff
    s_mov_b32 s32, s4
    s_and_b32 s33, s5, 0xffff
    s_mov_b32 s36, s10
    s_and_b32 s37, s11, 0xffff
    s_mov_b32 s55, s47
    s_cmp_lt_u32 s40, 3
    s_cbranch_scc1 L_nopf
    s_cmp_eq_u32 s40, 3
    s_cbranch_scc1 L_pfx
    v_lshrrev_b32 v4, 3, v1
    v_and_b32 v5, 7, v1
    v_lshlrev_b32 v5, 7, v5
    v_lshl_add_u32 v4, v4, 13, v5
    s_and_b32 s43, s40, 3
    s_lshl_b32 s43, s43, 5
    s_add_u32 s43, s43, s49
    s_lshl_b32 s43, s43, 16
    s_lshl_b32 s44, s48, 10
    s_add_u32 s43, s43, s44
    buffer_load_dword v68, v4, s[36:39], s43 offen
    s_branch L_nopf
L_pfx:
    v_lshlrev_b32 v4, 7, v1
    s_lshl_b32 s43, s49, 13
    buffer_load_dword v68, v4, s[32:35], s43 offen
L_nopf:
    s_barrier
    s_cmp_lt_u32 s48, 4
    s_cselect_b32 s98, 5, 5
    s_cselect_b32 s43, 5, 5
    s_cmp_lt_u32 s49, 16
    s_cselect_b32 s98, s98, s43
    s_cbranch_scc1 L_a_wait
    s_cmp_ge_u32 s40, 4
    s_cbranch_scc1 L_b_nov
L_wf_1:
    ds_read_b32 v4, v3 offset:0
    s_waitcnt lgkmcnt(0)
    v_readfirstlane_b32 s43, v4
    s_cmp_ge_u32 s43, s40
    s_cbranch_scc1 L_wd_2
    s_sleep 1
    s_sub_u32 s42, s42, 1
    s_cbranch_scc0 L_wf_1
    s_endpgm
L_wd_2:
    buffer_load_dwordx4 v[128:131], v2, s[24:27], s55 offen offset:0 nt
    buffer_load_dwordx4 v[132:135], v2, s[24:27], s55 offen offset:1024 nt
    buffer_load_dwordx4 v[136:139], v2, s[24:27], s55 offen offset:2048 nt
    buffer_load_dwordx4 v[140:143], v2, s[24:27], s55 offen offset:3072 nt
    s_add_u32 s55, s55, 4096
    buffer_load_dwordx4 v[144:147], v2, s[24:27], s55 offen offset:0 nt
    buffer_load_dwordx4 v[148:151], v2, s[24:27], s55 offen offset:1024 nt
    buffer_load_dwordx4 v[152:155], v2, s[24:27], s55 offen offset:2048 nt
    buffer_load_dwordx4 v[156:159], v2, s[24:27], s55 offen offset:3072 nt
    s_add_u32 s55, s55, 4096
    buffer_load_dwordx4 v[160:163], v2, s[24:27], s55 offen offset:0 nt
    buffer_load_dwordx4 v[164:167], v2, s[24:27], s55 offen offset:1024 nt
    buffer_load_dwordx4 v[168:171], v2, s[24:27], s55 offen offset:2048 nt
    buffer_load_dwordx4 v[172:175], v2, s[24:27], s55 offen offset:3072 nt
    s_add_u32 s55, s55, 4096
    buffer_load_dwordx4 v[176:179], v2, s[24:27], s55 offen offset:0 nt
    buffer_load_dwordx4 v[180:183], v2, s[24:27], s55 offen offset:1024 nt
    buffer_load_dwordx4 v[184:187], v2, s[24:27], s55 offen offset:2048 nt
    buffer_load_dwordx4 v[188:191], v2, s[24:27], s55 offen offset:3072 nt
    s_add_u32 s55, s55, 4096
    buffer_load_dwordx4 v[192:195], v2, s[24:27], s55 offen offset:0 nt
    buffer_load_dwordx4 v[196:199], v2, s[24:27], s55 offen offset:1024 nt
    buffer_load_dwordx4 v[200:203], v2, s[24:27], s55 offen offset:2048 nt
    buffer_load_dwordx4 v[204:207], v2, s[24:27], s55 offen offset:3072 nt
    s_add_u32 s55, s55, 4096
    buffer_load_dwordx4 v[208:211], v2, s[24:27], s55 offen offset:0 nt
    buffer_load_dwordx4 v[212:215], v2, s[24:27], s55 offen offset:1024 nt
    buffer_load_dwordx4 v[216:219], v2, s[24:27], s55 offen offset:2048 nt
    buffer_load_dwordx4 v[220:223], v2, s[24:27], s55 offen offset:3072 nt
    s_add_u32 s55, s55, 4096
    buffer_load_dwordx4 v[224:227], v2, s[24:27], s55 offen offset:0 nt
    buffer_load_dwordx4 v[228:231], v2, s[24:27], s55 offen offset:1024 nt
    buffer_load_dwordx4 v[232:235], v2, s[24:27], s55 offen offset:2048 nt
    buffer_load_dwordx4 v[236:239], v2, s[24:27], s55 offen offset:3072 nt
    s_add_u32 s55, s55, 4096
    buffer_load_dwordx4 v[240:243], v2, s[24:27], s55 offen offset:0 nt
    buffer_load_dwordx4 v[244:247], v2, s[24:27], s55 offen offset:1024 nt
    buffer_load_dwordx4 v[248:251], v2, s[24:27], s55 offen offset:2048 nt
    buffer_load_dwordx4 v[252:255], v2, s[24:27], s55 offen offset:3072 nt
    s_mov_b64 exec, 1
    ds_add_u32 v3, v14 offset:0
    s_mov_b64 exec, -1
    s_branch L_b_nov
L_a_wait:
L_b_nov:
L_qproj:
    v_lshrrev_b32 v4, 2, v1
    v_and_b32 v4, 4, v4
    v_and_b32 v5, 7, v1
    v_xor_b32 v4, v4, v5
    v_lshlrev_b32 v4, 4, v4
    v_lshrrev_b32 v5, 3, v1
    v_lshl_add_u32 v8, v5, 13, v4
    s_lshl_b32 s56, s48, 10
    s_and_b32 s43, s49, 7
    s_lshl_b32 s43, s43, 7
    s_add_u32 s56, s56, s43
    s_lshl_b32 s43, s40, 17
    s_add_u32 s56, s56, s43
    s_and_b32 s62, s49, 7
    s_lshl_b32 s54, s40, 11
    v_lshrrev_b32 v4, 4, v1
    s_and_b32 s43, s40, 3
    s_lshl_b32 s43, s43, 2
    v_add_u32 v5, s43, v4
    v_and_b32 v6, 15, v1
    v_xor_b32 v5, v5, v6
    v_lshlrev_b32 v5, 4, v5
    v_lshl_add_u32 v9, v4, 11, v5
    s_and_b32 s57, s49, 24
    s_add_u32 s57, s57, s40
    s_lshl_b32 s57, s57, 13
    s_lshl_b32 s45, s40, 10
    s_cmp_ge_u32 s49, 16
    s_cbranch_scc1 L_xlate
    s_xor_b32 s43, s62, 0
    s_lshl_b32 s43, s43, 8
    s_add_u32 m0, s45, 16384
    s_add_u32 s43, s43, s57
    buffer_load_dwordx4 v9, s[32:35], s43 offen lds
    s_xor_b32 s43, s62, 1
    s_lshl_b32 s43, s43, 8
    s_add_u32 m0, s45, 49152
    s_add_u32 s43, s43, s57
    buffer_load_dwordx4 v9, s[32:35], s43 offen lds
    s_xor_b32 s43, s62, 2
    s_lshl_b32 s43, s43, 8
    s_add_u32 m0, s45, 81920
    s_add_u32 s43, s43, s57
    buffer_load_dwordx4 v9, s[32:35], s43 offen lds
    s_xor_b32 s43, s62, 3
    s_lshl_b32 s43, s43, 8
    s_add_u32 m0, s45, 114688
    s_add_u32 s43, s43, s57
    buffer_load_dwordx4 v9, s[32:35], s43 offen lds
    s_xor_b32 s43, s62, 4
    s_lshl_b32 s43, s43, 8
    s_add_u32 m0, s45, 24576
    s_add_u32 s43, s43, s57
    buffer_load_dwordx4 v9, s[32:35], s43 offen lds
    s_xor_b32 s43, s62, 5
    s_lshl_b32 s43, s43, 8
    s_add_u32 m0, s45, 57344
    s_add_u32 s43, s43, s57
    buffer_load_dwordx4 v9, s[32:35], s43 offen lds
    s_xor_b32 s43, s62, 6
    s_lshl_b32 s43, s43, 8
    s_add_u32 m0, s45, 90112
    s_add_u32 s43, s43, s57
    buffer_load_dwordx4 v9, s[32:35], s43 offen lds
    s_xor_b32 s43, s62, 7
    s_lshl_b32 s43, s43, 8
    s_add_u32 m0, s45, 122880
    s_add_u32 s43, s43, s57
    buffer_load_dwordx4 v9, s[32:35], s43 offen lds
    s_waitcnt vmcnt(8)
L_xw:
    s_barrier
    s_branch L_xdone
L_xlate:
    s_barrier
    s_xor_b32 s43, s62, 0
    s_lshl_b32 s43, s43, 8
    s_add_u32 m0, s45, 16384
    s_add_u32 s43, s43, s57
    buffer_load_dwordx4 v9, s[32:35], s43 offen lds
    s_xor_b32 s43, s62, 1
    s_lshl_b32 s43, s43, 8
    s_add_u32 m0, s45, 49152
    s_add_u32 s43, s43, s57
    buffer_load_dwordx4 v9, s[32:35], s43 offen lds
    s_xor_b32 s43, s62, 2
    s_lshl_b32 s43, s43, 8
    s_add_u32 m0, s45, 81920
    s_add_u32 s43, s43, s57
    buffer_load_dwordx4 v9, s[32:35], s43 offen lds
    s_xor_b32 s43, s62, 3
    s_lshl_b32 s43, s43, 8
    s_add_u32 m0, s45, 114688
    s_add_u32 s43, s43, s57
    buffer_load_dwordx4 v9, s[32:35], s43 offen lds
    s_xor_b32 s43, s62, 4
    s_lshl_b32 s43, s43, 8
    s_add_u32 m0, s45, 24576
    s_add_u32 s43, s43, s57
    buffer_load_dwordx4 v9, s[32:35], s43 offen lds
    s_xor_b32 s43, s62, 5
    s_lshl_b32 s43, s43, 8
    s_add_u32 m0, s45, 57344
    s_add_u32 s43, s43, s57
    buffer_load_dwordx4 v9, s[32:35], s43 offen lds
    s_xor_b32 s43, s62, 6
    s_lshl_b32 s43, s43, 8
    s_add_u32 m0, s45, 90112
    s_add_u32 s43, s43, s57
    buffer_load_dwordx4 v9, s[32:35], s43 offen lds
    s_xor_b32 s43, s62, 7
    s_lshl_b32 s43, s43, 8
    s_add_u32 m0, s45, 122880
    s_add_u32 s43, s43, s57
    buffer_load_dwordx4 v9, s[32:35], s43 offen lds
L_xdone:
    s_xor_b32 s43, s62, 0
    s_lshl_b32 s43, s43, 20
    s_add_u32 m0, s54, 0
    s_add_u32 s43, s43, s56
    buffer_load_dwordx4 v8, s[36:39], s43 offen lds
    s_add_u32 m0, s54, 1024
    s_add_u32 s43, s43, 0x10000
    buffer_load_dwordx4 v8, s[36:39], s43 offen lds
    s_setprio 0
    s_xor_b32 s43, s62, 1
    s_lshl_b32 s43, s43, 20
    s_add_u32 m0, s54, 32768
    s_add_u32 s43, s43, s56
    buffer_load_dwordx4 v8, s[36:39], s43 offen lds
    s_add_u32 m0, s54, 33792
    s_add_u32 s43, s43, 0x10000
    buffer_load_dwordx4 v8, s[36:39], s43 offen lds
    s_xor_b32 s43, s62, 2
    s_lshl_b32 s43, s43, 20
    s_add_u32 m0, s54, 65536
    s_add_u32 s43, s43, s56
    buffer_load_dwordx4 v8, s[36:39], s43 offen lds
    s_add_u32 m0, s54, 66560
    s_add_u32 s43, s43, 0x10000
    buffer_load_dwordx4 v8, s[36:39], s43 offen lds
    s_xor_b32 s43, s62, 3
    s_lshl_b32 s43, s43, 20
    s_add_u32 m0, s54, 98304
    s_add_u32 s43, s43, s56
    buffer_load_dwordx4 v8, s[36:39], s43 offen lds
    s_add_u32 m0, s54, 99328
    s_add_u32 s43, s43, 0x10000
    buffer_load_dwordx4 v8, s[36:39], s43 offen lds
    v_and_b32 v4, 31, v1
    v_lshrrev_b32 v5, 5, v1
    s_and_b32 s43, s40, 6
    s_lshl_b32 s44, s43, 1
    v_add_u32 v6, s44, v5
    v_and_b32 v7, 15, v1
    v_xor_b32 v6, v6, v7
    v_lshlrev_b32 v6, 4, v6
    v_lshl_add_u32 v6, v4, 8, v6
    v_add_u32 v32, 0x4000, v6
    v_xor_b32 v33, 32, v32
    v_add_u32 v34, 0x10000, v32
    v_add_u32 v35, 0x10000, v33
    v_and_b32 v4, 1, v1
    v_lshlrev_b32 v4, 5, v4
    v_and_b32 v6, 16, v1
    v_or_b32 v4, v4, v6
    v_and_b32 v6, 2, v1
    v_lshl_or_b32 v4, v6, 2, v4
    v_and_b32 v6, 8, v1
    v_lshl_or_b32 v4, v6, 3, v4
    s_and_b32 s44, s40, 1
    s_lshl_b32 s44, s44, 6
    v_xor_b32 v4, s44, v4
    v_bfe_u32 v6, v1, 2, 2
    v_lshl_add_u32 v6, v5, 3, v6
    v_lshl_add_u32 v4, v6, 7, v4
    s_lshl_b32 s43, s43, 11
    v_add_u32 v36, s43, v4
    v_add_u32 v37, 0x10000, v36
    v_lshrrev_b32 v7, 4, v1
    v_lshlrev_b32 v7, 6, v7
    v_xor_b32 v16, v7, v2
    v_xor_b32 v17, 16, v16
    v_xor_b32 v18, 32, v16
    v_xor_b32 v19, 48, v16
    s_waitcnt vmcnt(6)
    s_barrier
    ds_read_b128 v[72:75], v32 offset:0
    ds_read_b64_tr_b16 v[88:89], v36 offset:0
    ds_read_b64_tr_b16 v[90:91], v36 offset:512
    ds_read_b128 v[76:79], v33 offset:0
    ds_read_b64_tr_b16 v[92:93], v36 offset:2048
    ds_read_b64_tr_b16 v[94:95], v36 offset:2560
    s_waitcnt lgkmcnt(3)
    v_mfma_f32_32x32x16_bf16 v[112:127], v[88:91], v[72:75], 0
    s_waitcnt lgkmcnt(0)
    v_mfma_f32_32x32x16_bf16 v[112:127], v[92:95], v[76:79], v[112:127]
    s_waitcnt vmcnt(4)
    s_barrier
    s_xor_b32 s43, s62, 4
    s_lshl_b32 s43, s43, 20
    s_add_u32 m0, s54, 0
    s_add_u32 s43, s43, s56
    buffer_load_dwordx4 v8, s[36:39], s43 offen lds
    s_add_u32 m0, s54, 1024
    s_add_u32 s43, s43, 0x10000
    buffer_load_dwordx4 v8, s[36:39], s43 offen lds
    ds_read_b128 v[72:75], v32 offset:32768
    ds_read_b64_tr_b16 v[88:89], v36 offset:32768
    ds_read_b64_tr_b16 v[90:91], v36 offset:33280
    ds_read_b128 v[76:79], v33 offset:32768
    ds_read_b64_tr_b16 v[92:93], v36 offset:34816
    ds_read_b64_tr_b16 v[94:95], v36 offset:35328
    s_waitcnt lgkmcnt(3)
    v_mfma_f32_32x32x16_bf16 v[112:127], v[88:91], v[72:75], v[112:127]
    s_waitcnt lgkmcnt(0)
    v_mfma_f32_32x32x16_bf16 v[112:127], v[92:95], v[76:79], v[112:127]
    s_waitcnt vmcnt(4)
    s_barrier
    s_xor_b32 s43, s62, 5
    s_lshl_b32 s43, s43, 20
    s_add_u32 m0, s54, 32768
    s_add_u32 s43, s43, s56
    buffer_load_dwordx4 v8, s[36:39], s43 offen lds
    s_add_u32 m0, s54, 33792
    s_add_u32 s43, s43, 0x10000
    buffer_load_dwordx4 v8, s[36:39], s43 offen lds
    ds_read_b128 v[72:75], v34 offset:0
    ds_read_b64_tr_b16 v[88:89], v37 offset:0
    ds_read_b64_tr_b16 v[90:91], v37 offset:512
    ds_read_b128 v[76:79], v35 offset:0
    ds_read_b64_tr_b16 v[92:93], v37 offset:2048
    ds_read_b64_tr_b16 v[94:95], v37 offset:2560
    s_waitcnt lgkmcnt(3)
    v_mfma_f32_32x32x16_bf16 v[112:127], v[88:91], v[72:75], v[112:127]
    s_waitcnt lgkmcnt(0)
    v_mfma_f32_32x32x16_bf16 v[112:127], v[92:95], v[76:79], v[112:127]
    s_waitcnt vmcnt(4)
    s_barrier
    s_xor_b32 s43, s62, 6
    s_lshl_b32 s43, s43, 20
    s_add_u32 m0, s54, 65536
    s_add_u32 s43, s43, s56
    buffer_load_dwordx4 v8, s[36:39], s43 offen lds
    s_add_u32 m0, s54, 66560
    s_add_u32 s43, s43, 0x10000
    buffer_load_dwordx4 v8, s[36:39], s43 offen lds
    ds_read_b128 v[72:75], v34 offset:32768
    ds_read_b64_tr_b16 v[88:89], v37 offset:32768
    ds_read_b64_tr_b16 v[90:91], v37 offset:33280
    ds_read_b128 v[76:79], v35 offset:32768
    ds_read_b64_tr_b16 v[92:93], v37 offset:34816
    ds_read_b64_tr_b16 v[94:95], v37 offset:35328
    s_waitcnt lgkmcnt(3)
    v_mfma_f32_32x32x16_bf16 v[112:127], v[88:91], v[72:75], v[112:127]
    s_waitcnt lgkmcnt(0)
    v_mfma_f32_32x32x16_bf16 v[112:127], v[92:95], v[76:79], v[112:127]
    s_waitcnt vmcnt(4)
    s_barrier
    s_xor_b32 s43, s62, 7
    s_lshl_b32 s43, s43, 20
    s_add_u32 m0, s54, 98304
    s_add_u32 s43, s43, s56
    buffer_load_dwordx4 v8, s[36:39], s43 offen lds
    s_add_u32 m0, s54, 99328
    s_add_u32 s43, s43, 0x10000
    buffer_load_dwordx4 v8, s[36:39], s43 offen lds
    ds_read_b128 v[72:75], v32 offset:8192
    ds_read_b64_tr_b16 v[88:89], v36 offset:0
    ds_read_b64_tr_b16 v[90:91], v36 offset:512
    ds_read_b128 v[76:79], v33 offset:8192
    ds_read_b64_tr_b16 v[92:93], v36 offset:2048
    ds_read_b64_tr_b16 v[94:95], v36 offset:2560
    s_waitcnt lgkmcnt(3)
    v_mfma_f32_32x32x16_bf16 v[112:127], v[88:91], v[72:75], v[112:127]
    s_waitcnt lgkmcnt(0)
    v_mfma_f32_32x32x16_bf16 v[112:127], v[92:95], v[76:79], v[112:127]
    s_waitcnt vmcnt(4)
    s_barrier
    ds_read_b128 v[72:75], v32 offset:40960
    ds_read_b64_tr_b16 v[88:89], v36 offset:32768
    ds_read_b64_tr_b16 v[90:91], v36 offset:33280
    ds_read_b128 v[76:79], v33 offset:40960
    ds_read_b64_tr_b16 v[92:93], v36 offset:34816
    ds_read_b64_tr_b16 v[94:95], v36 offset:35328
    s_waitcnt lgkmcnt(3)
    v_mfma_f32_32x32x16_bf16 v[112:127], v[88:91], v[72:75], v[112:127]
    s_waitcnt lgkmcnt(0)
    v_mfma_f32_32x32x16_bf16 v[112:127], v[92:95], v[76:79], v[112:127]
    s_cmp_lg_u32 s40, 0
    s_cbranch_scc1 L_noev
    s_mov_b32 m0, 0
    s_mov_b32 s55, s47
    buffer_load_dwordx4 v16, s[20:23], s55 offen offset:0 nt lds
    buffer_load_dwordx4 v17, s[20:23], s55 offen offset:1024 nt lds
    buffer_load_dwordx4 v18, s[20:23], s55 offen offset:2048 nt lds
    buffer_load_dwordx4 v19, s[20:23], s55 offen offset:3072 nt lds
    s_add_u32 m0, m0, 4096
    s_add_u32 s55, s55, 4096
    buffer_load_dwordx4 v16, s[20:23], s55 offen offset:0 nt lds
    buffer_load_dwordx4 v17, s[20:23], s55 offen offset:1024 nt lds
    buffer_load_dwordx4 v18, s[20:23], s55 offen offset:2048 nt lds
    buffer_load_dwordx4 v19, s[20:23], s55 offen offset:3072 nt lds
    s_add_u32 m0, m0, 4096
    s_add_u32 s55, s55, 4096
    buffer_load_dwordx4 v16, s[20:23], s55 offen offset:0 nt lds
    buffer_load_dwordx4 v17, s[20:23], s55 offen offset:1024 nt lds
    buffer_load_dwordx4 v18, s[20:23], s55 offen offset:2048 nt lds
    buffer_load_dwordx4 v19, s[20:23], s55 offen offset:3072 nt lds
    s_add_u32 m0, m0, 4096
    s_add_u32 s55, s55, 4096
    buffer_load_dwordx4 v16, s[20:23], s55 offen offset:0 nt lds
    buffer_load_dwordx4 v17, s[20:23], s55 offen offset:1024 nt lds
    buffer_load_dwordx4 v18, s[20:23], s55 offen offset:2048 nt lds
    buffer_load_dwordx4 v19, s[20:23], s55 offen offset:3072 nt lds
    s_add_u32 m0, m0, 4096
    s_add_u32 s55, s55, 4096
    buffer_load_dwordx4 v16, s[20:23], s55 offen offset:0 nt lds
    buffer_load_dwordx4 v17, s[20:23], s55 offen offset:1024 nt lds
    buffer_load_dwordx4 v18, s[20:23], s55 offen offset:2048 nt lds
    buffer_load_dwordx4 v19, s[20:23], s55 offen offset:3072 nt lds
    s_add_u32 m0, m0, 4096
    s_add_u32 s55, s55, 4096
    buffer_load_dwordx4 v16, s[20:23], s55 offen offset:0 nt lds
    buffer_load_dwordx4 v17, s[20:23], s55 offen offset:1024 nt lds
    buffer_load_dwordx4 v18, s[20:23], s55 offen offset:2048 nt lds
    buffer_load_dwordx4 v19, s[20:23], s55 offen offset:3072 nt lds
    s_add_u32 m0, m0, 4096
    s_add_u32 s55, s55, 4096
    buffer_load_dwordx4 v16, s[20:23], s55 offen offset:0 nt lds
    buffer_load_dwordx4 v17, s[20:23], s55 offen offset:1024 nt lds
    buffer_load_dwordx4 v18, s[20:23], s55 offen offset:2048 nt lds
    buffer_load_dwordx4 v19, s[20:23], s55 offen offset:3072 nt lds
    s_add_u32 m0, m0, 4096
    s_add_u32 s55, s55, 4096
    buffer_load_dwordx4 v16, s[20:23], s55 offen offset:0 nt lds
    buffer_load_dwordx4 v17, s[20:23], s55 offen offset:1024 nt lds
    buffer_load_dwordx4 v18, s[20:23], s55 offen offset:2048 nt lds
    buffer_load_dwordx4 v19, s[20:23], s55 offen offset:3072 nt lds
L_noev:
    s_cmp_eq_u32 s40, 0
    s_cbranch_scc1 L_qw_3
    s_waitcnt vmcnt(2)
L_qw_3:
    s_waitcnt vmcnt(34)
    s_barrier
    ds_read_b128 v[72:75], v34 offset:8192
    ds_read_b64_tr_b16 v[88:89], v37 offset:0
    ds_read_b64_tr_b16 v[90:91], v37 offset:512
    ds_read_b128 v[76:79], v35 offset:8192
    ds_read_b64_tr_b16 v[92:93], v37 offset:2048
    ds_read_b64_tr_b16 v[94:95], v37 offset:2560
    s_waitcnt lgkmcnt(3)
    v_mfma_f32_32x32x16_bf16 v[112:127], v[88:91], v[72:75], v[112:127]
    s_waitcnt lgkmcnt(0)
    v_mfma_f32_32x32x16_bf16 v[112:127], v[92:95], v[76:79], v[112:127]
    s_cmp_eq_u32 s40, 0
    s_cbranch_scc1 L_qw_5
    s_waitcnt vmcnt(0)
L_qw_5:
    s_waitcnt vmcnt(32)
    s_barrier
    ds_read_b128 v[72:75], v34 offset:40960
    ds_read_b64_tr_b16 v[88:89], v37 offset:32768
    ds_read_b64_tr_b16 v[90:91], v37 offset:33280
    ds_read_b128 v[76:79], v35 offset:40960
    ds_read_b64_tr_b16 v[92:93], v37 offset:34816
    ds_read_b64_tr_b16 v[94:95], v37 offset:35328
    s_waitcnt lgkmcnt(3)
    v_mfma_f32_32x32x16_bf16 v[112:127], v[88:91], v[72:75], v[112:127]
    s_waitcnt lgkmcnt(0)
    v_mfma_f32_32x32x16_bf16 v[112:127], v[92:95], v[76:79], v[112:127]
    s_cmp_ge_u32 s40, 6
    s_cbranch_scc1 L_q_pub
    s_lshl_b32 s43, s40, 12
    s_add_u32 s43, s43, 0x10000
    v_add_u32 v4, s43, v2
    s_nop 7
    ds_write_b128 v4, v[112:115] offset:0
    ds_write_b128 v4, v[116:119] offset:1024
    ds_write_b128 v4, v[120:123] offset:2048
    ds_write_b128 v4, v[124:127] offset:3072
    s_waitcnt lgkmcnt(0)
    s_barrier
    s_cmp_ge_u32 s40, s98
    s_cbranch_scc1 L_front_done
    s_cmp_ge_u32 s49, 16
    s_cselect_b32 s43, 4, 0
    s_cmp_lt_u32 s40, s43
    s_cbranch_scc1 L_b_sig
L_wf_7:
    ds_read_b32 v4, v3 offset:0
    s_waitcnt lgkmcnt(0)
    v_readfirstlane_b32 s43, v4
    s_cmp_ge_u32 s43, s40
    s_cbranch_scc1 L_wd_8
    s_sleep 1
    s_sub_u32 s42, s42, 1
    s_cbranch_scc0 L_wf_7
    s_endpgm
L_wd_8:
    s_mov_b32 s55, s47
    s_lshl_b32 s44, s40, 3
    s_add_u32 s44, s44, 65
    s_sub_u32 s44, s44, 64
    s_cmp_lt_u32 s49, 16
    s_cselect_b32 s45, 8, 0
    s_cmp_lt_u32 s40, s45
    s_cbranch_scc1 L_fv_free
L_wf_9:
    ds_read_b32 v4, v3 offset:16
    s_waitcnt lgkmcnt(0)
    v_readfirstlane_b32 s43, v4
    s_cmp_ge_u32 s43, s44
    s_cbranch_scc1 L_wd_10
    s_sleep 1
    s_sub_u32 s42, s42, 1
    s_cbranch_scc0 L_wf_9
    s_endpgm
L_wd_10:
    buffer_load_dwordx4 v[128:131], v2, s[24:27], s55 offen offset:0 nt
    buffer_load_dwordx4 v[132:135], v2, s[24:27], s55 offen offset:1024 nt
    buffer_load_dwordx4 v[136:139], v2, s[24:27], s55 offen offset:2048 nt
    buffer_load_dwordx4 v[140:143], v2, s[24:27], s55 offen offset:3072 nt
    s_add_u32 s55, s55, 4096
    s_add_u32 s44, s44, 1
L_wf_11:
    ds_read_b32 v4, v3 offset:16
    s_waitcnt lgkmcnt(0)
    v_readfirstlane_b32 s43, v4
    s_cmp_ge_u32 s43, s44
    s_cbranch_scc1 L_wd_12
    s_sleep 1
    s_sub_u32 s42, s42, 1
    s_cbranch_scc0 L_wf_11
    s_endpgm
L_wd_12:
    buffer_load_dwordx4 v[144:147], v2, s[24:27], s55 offen offset:0 nt
    buffer_load_dwordx4 v[148:151], v2, s[24:27], s55 offen offset:1024 nt
    buffer_load_dwordx4 v[152:155], v2, s[24:27], s55 offen offset:2048 nt
    buffer_load_dwordx4 v[156:159], v2, s[24:27], s55 offen offset:3072 nt
    s_add_u32 s55, s55, 4096
    s_add_u32 s44, s44, 1
L_wf_13:
    ds_read_b32 v4, v3 offset:16
    s_waitcnt lgkmcnt(0)
    v_readfirstlane_b32 s43, v4
    s_cmp_ge_u32 s43, s44
    s_cbranch_scc1 L_wd_14
    s_sleep 1
    s_sub_u32 s42, s42, 1
    s_cbranch_scc0 L_wf_13
    s_endpgm
L_wd_14:
    buffer_load_dwordx4 v[160:163], v2, s[24:27], s55 offen offset:0 nt
    buffer_load_dwordx4 v[164:167], v2, s[24:27], s55 offen offset:1024 nt
    buffer_load_dwordx4 v[168:171], v2, s[24:27], s55 offen offset:2048 nt
    buffer_load_dwordx4 v[172:175], v2, s[24:27], s55 offen offset:3072 nt
    s_add_u32 s55, s55, 4096
    s_add_u32 s44, s44, 1
L_wf_15:
    ds_read_b32 v4, v3 offset:16
    s_waitcnt lgkmcnt(0)
    v_readfirstlane_b32 s43, v4
    s_cmp_ge_u32 s43, s44
    s_cbranch_scc1 L_wd_16
    s_sleep 1
    s_sub_u32 s42, s42, 1
    s_cbranch_scc0 L_wf_15
    s_endpgm
L_wd_16:
    buffer_load_dwordx4 v[176:179], v2, s[24:27], s55 offen offset:0 nt
    buffer_load_dwordx4 v[180:183], v2, s[24:27], s55 offen offset:1024 nt
    buffer_load_dwordx4 v[184:187], v2, s[24:27], s55 offen offset:2048 nt
    buffer_load_dwordx4 v[188:191], v2, s[24:27], s55 offen offset:3072 nt
    s_add_u32 s55, s55, 4096
    s_add_u32 s44, s44, 1
L_wf_17:
    ds_read_b32 v4, v3 offset:16
    s_waitcnt lgkmcnt(0)
    v_readfirstlane_b32 s43, v4
    s_cmp_ge_u32 s43, s44
    s_cbranch_scc1 L_wd_18
    s_sleep 1
    s_sub_u32 s42, s42, 1
    s_cbranch_scc0 L_wf_17
    s_endpgm
L_wd_18:
    buffer_load_dwordx4 v[192:195], v2, s[24:27], s55 offen offset:0 nt
    buffer_load_dwordx4 v[196:199], v2, s[24:27], s55 offen offset:1024 nt
    buffer_load_dwordx4 v[200:203], v2, s[24:27], s55 offen offset:2048 nt
    buffer_load_dwordx4 v[204:207], v2, s[24:27], s55 offen offset:3072 nt
    s_add_u32 s55, s55, 4096
    s_add_u32 s44, s44, 1
L_wf_19:
    ds_read_b32 v4, v3 offset:16
    s_waitcnt lgkmcnt(0)
    v_readfirstlane_b32 s43, v4
    s_cmp_ge_u32 s43, s44
    s_cbranch_scc1 L_wd_20
    s_sleep 1
    s_sub_u32 s42, s42, 1
    s_cbranch_scc0 L_wf_19
    s_endpgm
L_wd_20:
    buffer_load_dwordx4 v[208:211], v2, s[24:27], s55 offen offset:0 nt
    buffer_load_dwordx4 v[212:215], v2, s[24:27], s55 offen offset:1024 nt
    buffer_load_dwordx4 v[216:219], v2, s[24:27], s55 offen offset:2048 nt
    buffer_load_dwordx4 v[220:223], v2, s[24:27], s55 offen offset:3072 nt
    s_add_u32 s55, s55, 4096
    s_add_u32 s44, s44, 1
L_wf_21:
    ds_read_b32 v4, v3 offset:16
    s_waitcnt lgkmcnt(0)
    v_readfirstlane_b32 s43, v4
    s_cmp_ge_u32 s43, s44
    s_cbranch_scc1 L_wd_22
    s_sleep 1
    s_sub_u32 s42, s42, 1
    s_cbranch_scc0 L_wf_21
    s_endpgm
L_wd_22:
    buffer_load_dwordx4 v[224:227], v2, s[24:27], s55 offen offset:0 nt
    buffer_load_dwordx4 v[228:231], v2, s[24:27], s55 offen offset:1024 nt
    buffer_load_dwordx4 v[232:235], v2, s[24:27], s55 offen offset:2048 nt
    buffer_load_dwordx4 v[236:239], v2, s[24:27], s55 offen offset:3072 nt
    s_add_u32 s55, s55, 4096
    s_add_u32 s44, s44, 1
L_wf_23:
    ds_read_b32 v4, v3 offset:16
    s_waitcnt lgkmcnt(0)
    v_readfirstlane_b32 s43, v4
    s_cmp_ge_u32 s43, s44
    s_cbranch_scc1 L_wd_24
    s_sleep 1
    s_sub_u32 s42, s42, 1
    s_cbranch_scc0 L_wf_23
    s_endpgm
L_wd_24:
    buffer_load_dwordx4 v[240:243], v2, s[24:27], s55 offen offset:0 nt
    buffer_load_dwordx4 v[244:247], v2, s[24:27], s55 offen offset:1024 nt
    buffer_load_dwordx4 v[248:251], v2, s[24:27], s55 offen offset:2048 nt
    buffer_load_dwordx4 v[252:255], v2, s[24:27], s55 offen offset:3072 nt
    s_branch L_fv_done
L_fv_free:
    buffer_load_dwordx4 v[128:131], v2, s[24:27], s55 offen offset:0 nt
    buffer_load_dwordx4 v[132:135], v2, s[24:27], s55 offen offset:1024 nt
    buffer_load_dwordx4 v[136:139], v2, s[24:27], s55 offen offset:2048 nt
    buffer_load_dwordx4 v[140:143], v2, s[24:27], s55 offen offset:3072 nt
    s_add_u32 s55, s55, 4096
    buffer_load_dwordx4 v[144:147], v2, s[24:27], s55 offen offset:0 nt
    buffer_load_dwordx4 v[148:151], v2, s[24:27], s55 offen offset:1024 nt
    buffer_load_dwordx4 v[152:155], v2, s[24:27], s55 offen offset:2048 nt
    buffer_load_dwordx4 v[156:159], v2, s[24:27], s55 offen offset:3072 nt
    s_add_u32 s55, s55, 4096
    buffer_load_dwordx4 v[160:163], v2, s[24:27], s55 offen offset:0 nt
    buffer_load_dwordx4 v[164:167], v2, s[24:27], s55 offen offset:1024 nt
    buffer_load_dwordx4 v[168:171], v2, s[24:27], s55 offen offset:2048 nt
    buffer_load_dwordx4 v[172:175], v2, s[24:27], s55 offen offset:3072 nt
    s_add_u32 s55, s55, 4096
    buffer_load_dwordx4 v[176:179], v2, s[24:27], s55 offen offset:0 nt
    buffer_load_dwordx4 v[180:183], v2, s[24:27], s55 offen offset:1024 nt
    buffer_load_dwordx4 v[184:187], v2, s[24:27], s55 offen offset:2048 nt
    buffer_load_dwordx4 v[188:191], v2, s[24:27], s55 offen offset:3072 nt
    s_add_u32 s55, s55, 4096
    buffer_load_dwordx4 v[192:195], v2, s[24:27], s55 offen offset:0 nt
    buffer_load_dwordx4 v[196:199], v2, s[24:27], s55 offen offset:1024 nt
    buffer_load_dwordx4 v[200:203], v2, s[24:27], s55 offen offset:2048 nt
    buffer_load_dwordx4 v[204:207], v2, s[24:27], s55 offen offset:3072 nt
    s_add_u32 s55, s55, 4096
    buffer_load_dwordx4 v[208:211], v2, s[24:27], s55 offen offset:0 nt
    buffer_load_dwordx4 v[212:215], v2, s[24:27], s55 offen offset:1024 nt
    buffer_load_dwordx4 v[216:219], v2, s[24:27], s55 offen offset:2048 nt
    buffer_load_dwordx4 v[220:223], v2, s[24:27], s55 offen offset:3072 nt
    s_add_u32 s55, s55, 4096
    buffer_load_dwordx4 v[224:227], v2, s[24:27], s55 offen offset:0 nt
    buffer_load_dwordx4 v[228:231], v2, s[24:27], s55 offen offset:1024 nt
    buffer_load_dwordx4 v[232:235], v2, s[24:27], s55 offen offset:2048 nt
    buffer_load_dwordx4 v[236:239], v2, s[24:27], s55 offen offset:3072 nt
    s_add_u32 s55, s55, 4096
    s_waitcnt vmcnt(59)
    buffer_load_dwordx4 v[240:243], v2, s[24:27], s55 offen offset:0 nt
    buffer_load_dwordx4 v[244:247], v2, s[24:27], s55 offen offset:1024 nt
    buffer_load_dwordx4 v[248:251], v2, s[24:27], s55 offen offset:2048 nt
    buffer_load_dwordx4 v[252:255], v2, s[24:27], s55 offen offset:3072 nt
L_fv_done:
    s_mov_b64 exec, 1
    ds_add_u32 v3, v14 offset:0
    s_mov_b64 exec, -1
    s_cmp_lg_u32 s40, 0
    s_cbranch_scc1 L_sig4
    s_waitcnt vmcnt(32)
    v_mov_b32 v4, 8
    s_mov_b64 exec, 1
    ds_add_u32 v3, v4 offset:16
    s_mov_b64 exec, -1
    s_branch L_sig4
L_b_sig:
    v_mov_b32 v4, 8
    s_mov_b64 exec, 1
    ds_add_u32 v3, v4 offset:16
    s_mov_b64 exec, -1
    s_cmp_lg_u32 s40, 0
    s_cbranch_scc1 L_front_done
L_sig4:
    s_waitcnt vmcnt(28)
    s_mov_b64 exec, 1
    ds_add_u32 v3, v14 offset:16
    s_mov_b64 exec, -1
    s_waitcnt vmcnt(24)
    s_mov_b64 exec, 1
    ds_add_u32 v3, v14 offset:16
    s_mov_b64 exec, -1
    s_waitcnt vmcnt(20)
    s_mov_b64 exec, 1
    ds_add_u32 v3, v14 offset:16
    s_mov_b64 exec, -1
    s_waitcnt vmcnt(16)
    s_mov_b64 exec, 1
    ds_add_u32 v3, v14 offset:16
    s_mov_b64 exec, -1
    s_waitcnt vmcnt(12)
    s_mov_b64 exec, 1
    ds_add_u32 v3, v14 offset:16
    s_mov_b64 exec, -1
    s_waitcnt vmcnt(8)
    s_mov_b64 exec, 1
    ds_add_u32 v3, v14 offset:16
    s_mov_b64 exec, -1
    s_waitcnt vmcnt(4)
    s_mov_b64 exec, 1
    ds_add_u32 v3, v14 offset:16
    s_mov_b64 exec, -1
    s_waitcnt vmcnt(0)
    s_mov_b64 exec, 1
    ds_add_u32 v3, v14 offset:16
    s_mov_b64 exec, -1
    s_branch L_front_done
L_q_pub:
    s_setprio 3
    s_and_b32 s44, s40, 1
    s_lshl_b32 s43, s44, 12
    s_add_u32 s43, s43, 0x10000
    v_add_u32 v4, s43, v2
    v_bfe_u32 v6, v1, 2, 3
    v_lshlrev_b32 v6, 7, v6
    v_and_b32 v7, 3, v1
    v_lshl_add_u32 v7, v5, 2, v7
    v_lshl_add_u32 v6, v7, 4, v6
    s_and_b32 s43, s49, 24
    s_add_u32 s43, s43, s48
    s_lshl_b32 s43, s43, 3
    s_and_b32 s45, s49, 7
    s_add_u32 s43, s43, s45
    s_lshl_b32 s43, s43, 1
    s_add_u32 s43, s43, s44
    s_mul_i32 s43, s43, 3072
    s_add_u32 s43, s43, 0x40000
    s_add_u32 s44, s43, 1024
    s_add_u32 s45, s43, 2048
    s_mul_i32 s58, s41, 0x9e3779b1
    s_add_u32 s58, s58, 0x7f4a7c15
    v_mov_b32 v43, s58
    v_mov_b32 v47, s58
    v_mov_b32 v51, s58
    s_barrier
    ds_read_b128 v[64:67], v4 offset:0
    ds_read_b128 v[68:71], v4 offset:1024
    ds_read_b128 v[72:75], v4 offset:2048
    ds_read_b128 v[76:79], v4 offset:3072
    ds_read_b128 v[80:83], v4 offset:8192
    ds_read_b128 v[84:87], v4 offset:9216
    ds_read_b128 v[88:91], v4 offset:10240
    ds_read_b128 v[92:95], v4 offset:11264
    ds_read_b128 v[96:99], v4 offset:16384
    ds_read_b128 v[100:103], v4 offset:17408
    ds_read_b128 v[104:107], v4 offset:18432
    ds_read_b128 v[108:111], v4 offset:19456
    s_waitcnt lgkmcnt(11)
    v_add_f32 v112, v112, v64
    v_add_f32 v113, v113, v65
    v_add_f32 v114, v114, v66
    v_add_f32 v115, v115, v67
    s_waitcnt lgkmcnt(10)
    v_add_f32 v116, v116, v68
    v_add_f32 v117, v117, v69
    v_add_f32 v118, v118, v70
    v_add_f32 v119, v119, v71
    s_waitcnt lgkmcnt(9)
    v_add_f32 v120, v120, v72
    v_add_f32 v121, v121, v73
    v_add_f32 v122, v122, v74
    v_add_f32 v123, v123, v75
    s_waitcnt lgkmcnt(8)
    v_add_f32 v124, v124, v76
    v_add_f32 v125, v125, v77
    v_add_f32 v126, v126, v78
    v_add_f32 v127, v127, v79
    s_waitcnt lgkmcnt(7)
    v_add_f32 v112, v112, v80
    v_add_f32 v113, v113, v81
    v_add_f32 v114, v114, v82
    v_add_f32 v115, v115, v83
    s_waitcnt lgkmcnt(6)
    v_add_f32 v116, v116, v84
    v_add_f32 v117, v117, v85
    v_add_f32 v118, v118, v86
    v_add_f32 v119, v119, v87
    s_waitcnt lgkmcnt(5)
    v_add_f32 v120, v120, v88
    v_add_f32 v121, v121, v89
    v_add_f32 v122, v122, v90
    v_add_f32 v123, v123, v91
    s_waitcnt lgkmcnt(4)
    v_add_f32 v124, v124, v92
    v_add_f32 v125, v125, v93
    v_add_f32 v126, v126, v94
    v_add_f32 v127, v127, v95
    s_waitcnt lgkmcnt(3)
    v_add_f32 v112, v112, v96
    v_add_f32 v113, v113, v97
    v_add_f32 v114, v114, v98
    v_add_f32 v115, v115, v99
    s_waitcnt lgkmcnt(2)
    v_add_f32 v116, v116, v100
    v_add_f32 v117, v117, v101
    v_add_f32 v118, v118, v102
    v_add_f32 v119, v119, v103
    s_waitcnt lgkmcnt(1)
    v_add_f32 v120, v120, v104
    v_add_f32 v121, v121, v105
    v_add_f32 v122, v122, v106
    v_add_f32 v123, v123, v107
    s_waitcnt lgkmcnt(0)
    v_add_f32 v124, v124, v108
    v_add_f32 v125, v125, v109
    v_add_f32 v126, v126, v110
    v_add_f32 v127, v127, v111
    v_cvt_pk_bf16_f32 v40, v112, v113
    v_cvt_pk_bf16_f32 v41, v114, v115
    v_cvt_pk_bf16_f32 v42, v116, v117
    v_cvt_pk_bf16_f32 v48, v118, v119
    v_cvt_pk_bf16_f32 v44, v120, v121
    v_cvt_pk_bf16_f32 v45, v122, v123
    v_cvt_pk_bf16_f32 v46, v124, v125
    v_cvt_pk_bf16_f32 v49, v126, v127
    s_mov_b64 exec, 1
    ds_add_u32 v3, v14 offset:20
    s_mov_b64 exec, -1
    s_mov_b32 s58, s43
    s_cmp_ge_u32 s49, 16
    s_cbranch_scc1 L_qnow
L_wf_25:
    ds_read_b32 v4, v3 offset:16
    s_waitcnt lgkmcnt(0)
    v_readfirstlane_b32 s43, v4
    s_cmp_ge_u32 s43, 24
    s_cbranch_scc1 L_wd_26
    s_sleep 1
    s_sub_u32 s42, s42, 1
    s_cbranch_scc0 L_wf_25
    s_endpgm
L_wd_26:
L_qnow:
    s_mov_b32 s43, s58
    buffer_store_dwordx4 v[40:43], v6, s[28:31], s43 offen sc1
    buffer_store_dwordx4 v[44:47], v6, s[28:31], s44 offen sc1
    buffer_store_dwordx4 v[48:51], v6, s[28:31], s45 offen sc1
    s_setprio 0
L_front_done:
    s_waitcnt lgkmcnt(0)
    s_mul_i32 s41, s41, 0x9e3779b1
    s_add_u32 s41, s41, 0x7f4a7c15
    s_mov_b32 s51, 0x05040100
    s_mov_b32 s52, 0x07060302
    s_mov_b32 s53, 0x3e0293ee
    s_mov_b32 s32, s12
    s_and_b32 s33, s13, 0xffff
    s_mov_b32 s34, 0x800000
    s_mov_b32 s36, s14
    s_and_b32 s37, s15, 0xffff
    s_mov_b32 s38, 0x40000
    s_cmp_lg_u32 s40, 5
    s_cbranch_scc1 L_notouch
    v_lshlrev_b32 v5, 18, v1
    s_lshr_b32 s44, s49, 3
    s_mul_i32 s44, s44, 786432
    s_add_u32 s44, s44, 0x200000
    s_mov_b32 exec_lo, 0xf
    s_mov_b32 exec_hi, 0x0
    buffer_load_dword v64, v5, s[28:31], s44 offen sc1
    s_mov_b32 exec_lo, 0x1
    s_mov_b32 exec_hi, 0x0
    s_lshl_b32 s44, s49, 17
    s_add_u32 s44, s44, 0x600000
    buffer_load_dword v64, v5, s[28:31], s44 offen sc1
    s_mov_b64 exec, 1
    s_mul_i32 s44, s50, 12288
    s_add_u32 s44, s44, 0x200000
    buffer_load_dword v64, v5, s[28:31], s44 offen sc1
    s_and_b32 s44, s49, 24
    s_add_u32 s44, s44, s48
    s_lshl_b32 s44, s44, 13
    buffer_load_dword v64, v5, s[36:39], s44 offen sc1
    s_mov_b64 exec, -1
L_notouch:
    s_cmp_lt_u32 s40, 6
    s_cbranch_scc1 L_no_qpoll
    v_lshrrev_b32 v5, 4, v1
    v_lshlrev_b32 v6, 5, v5
    v_and_b32 v7, 0xff, v2
    v_xor_b32 v6, v6, v7
    v_lshl_add_u32 v12, v5, 11, v6
    v_xor_b32 v13, 0x80, v12
    s_lshl_b32 s99, s48, 20
    s_and_b32 s44, s49, 7
    s_lshl_b32 s44, s44, 8
    s_add_u32 s99, s99, s44
    s_and_b32 s44, s40, 1
    s_lshl_b32 s44, s44, 17
    s_add_u32 s99, s99, s44
    s_cmp_lt_u32 s48, 4
    s_cselect_b32 s44, 44, 44
    s_cselect_b32 s43, 46, 46
    s_cmp_lt_u32 s49, 16
    s_cselect_b32 s44, s44, s43
L_wf_27:
    ds_read_b32 v4, v3 offset:16
    s_waitcnt lgkmcnt(0)
    v_readfirstlane_b32 s43, v4
    s_cmp_ge_u32 s43, s44
    s_cbranch_scc1 L_wd_28
    s_sleep 1
    s_sub_u32 s42, s42, 1
    s_cbranch_scc0 L_wf_27
    s_endpgm
L_wd_28:
    s_setprio 3
    s_lshr_b32 s44, s50, 6
    s_lshl_b32 s44, s44, 2
    s_bfe_u32 s45, s50, 0x20001
    s_add_u32 s44, s44, s45
    s_lshl_b32 s44, s44, 1
    s_and_b32 s43, s40, 1
    s_add_u32 s44, s44, s43
    s_mul_i32 s44, s44, 49152
    s_bfe_u32 s45, s50, 0x30003
    s_lshl_b32 s45, s45, 7
    s_add_u32 s44, s44, s45
    s_add_u32 s44, s44, 0x40000
    s_add_u32 s45, s44, 24576
    s_lshl_b32 s43, s43, 11
    v_lshrrev_b32 v5, 3, v1
    v_mul_u32_u24 v5, 3072, v5
    v_and_b32 v6, 0x70, v2
    v_add_u32 v5, v5, v6
L_qpoll:
    buffer_load_dwordx4 v[64:67], v5, s[28:31], s44 offen offset:0 sc1
    buffer_load_dwordx4 v[68:71], v5, s[28:31], s44 offen offset:1024 sc1
    buffer_load_dwordx4 v[72:75], v5, s[28:31], s44 offen offset:2048 sc1
    buffer_load_dwordx4 v[76:79], v5, s[28:31], s45 offen offset:0 sc1
    buffer_load_dwordx4 v[80:83], v5, s[28:31], s45 offen offset:1024 sc1
    buffer_load_dwordx4 v[84:87], v5, s[28:31], s45 offen offset:2048 sc1
    s_waitcnt vmcnt(0)
    v_cmp_ne_u32 vcc, s41, v67
    s_mov_b64 s[60:61], vcc
    v_cmp_ne_u32 vcc, s41, v71
    s_or_b64 s[60:61], s[60:61], vcc
    v_cmp_ne_u32 vcc, s41, v75
    s_or_b64 s[60:61], s[60:61], vcc
    v_cmp_ne_u32 vcc, s41, v79
    s_or_b64 s[60:61], s[60:61], vcc
    v_cmp_ne_u32 vcc, s41, v83
    s_or_b64 s[60:61], s[60:61], vcc
    v_cmp_ne_u32 vcc, s41, v87
    s_or_b64 s[60:61], s[60:61], vcc
    s_cbranch_scc0 L_qok
    s_sleep 4
    s_sleep 1
    s_sub_u32 s42, s42, 1
    s_cbranch_scc0 L_qpoll
    s_endpgm
L_qok:
    v_bfe_u32 v4, v1, 3, 2
    v_lshlrev_b32 v4, 10, v4
    v_and_b32 v5, 4, v1
    v_lshl_or_b32 v4, v5, 7, v4
    v_and_b32 v5, 32, v1
    v_lshl_or_b32 v4, v5, 1, v4
    v_and_b32 v5, 3, v1
    v_lshl_or_b32 v4, v5, 4, v4
    s_lshl_b32 s43, s43, 1
    s_add_u32 s43, s43, 131072
    v_add_u32 v4, s43, v4
    v_mov_b32 v67, v72
    v_mov_b32 v71, v73
    ds_write_b128 v4, v[64:67] offset:0
    ds_write_b128 v4, v[68:71] offset:256
    v_mov_b32 v79, v84
    v_mov_b32 v83, v85
    ds_write_b128 v4, v[76:79] offset:128
    ds_write_b128 v4, v[80:83] offset:384
    s_waitcnt lgkmcnt(0)
    s_mov_b64 exec, 1
    ds_add_u32 v3, v14 offset:4
    s_mov_b64 exec, -1
    s_setprio 0
L_wf_29:
    ds_read_b32 v4, v3 offset:72
    s_waitcnt lgkmcnt(0)
    v_readfirstlane_b32 s43, v4
    s_cmp_ge_u32 s43, 1
    s_cbranch_scc1 L_wd_30
    s_sleep 1
    s_sub_u32 s42, s42, 1
    s_cbranch_scc0 L_wf_29
    s_endpgm
L_wd_30:
    s_and_b32 s44, s40, 1
    s_lshl_b32 s44, s44, 14
    s_add_u32 m0, s44, 65536
    s_add_u32 s44, s99, 0
    s_waitcnt vmcnt(7)
    buffer_load_dwordx4 v12, s[32:35], s44 offen lds
    s_add_u32 m0, m0, 1024
    s_add_u32 s44, s44, 8192
    s_waitcnt vmcnt(7)
    buffer_load_dwordx4 v12, s[32:35], s44 offen lds
    s_add_u32 m0, m0, 1024
    s_add_u32 s44, s44, 8192
    s_waitcnt vmcnt(7)
    buffer_load_dwordx4 v12, s[32:35], s44 offen lds
    s_add_u32 m0, m0, 1024
    s_add_u32 s44, s44, 8192
    s_waitcnt vmcnt(7)
    buffer_load_dwordx4 v12, s[32:35], s44 offen lds
    s_add_u32 m0, m0, 1024
    s_add_u32 s44, s44, 8192
    s_waitcnt vmcnt(7)
    buffer_load_dwordx4 v12, s[32:35], s44 offen lds
    s_add_u32 m0, m0, 1024
    s_add_u32 s44, s44, 8192
    s_waitcnt vmcnt(7)
    buffer_load_dwordx4 v12, s[32:35], s44 offen lds
    s_add_u32 m0, m0, 1024
    s_add_u32 s44, s44, 8192
    s_waitcnt vmcnt(7)
    buffer_load_dwordx4 v12, s[32:35], s44 offen lds
    s_add_u32 m0, m0, 1024
    s_add_u32 s44, s44, 8192
    s_waitcnt vmcnt(7)
    buffer_load_dwordx4 v12, s[32:35], s44 offen lds
    s_add_u32 m0, m0, 1024
    s_add_u32 s44, s44, 8192
    s_waitcnt vmcnt(7)
    buffer_load_dwordx4 v13, s[32:35], s44 offen lds
    s_add_u32 m0, m0, 1024
    s_add_u32 s44, s44, 8192
    s_waitcnt vmcnt(7)
    buffer_load_dwordx4 v13, s[32:35], s44 offen lds
    s_add_u32 m0, m0, 1024
    s_add_u32 s44, s44, 8192
    s_waitcnt vmcnt(7)
    buffer_load_dwordx4 v13, s[32:35], s44 offen lds
    s_add_u32 m0, m0, 1024
    s_add_u32 s44, s44, 8192
    s_waitcnt vmcnt(7)
    buffer_load_dwordx4 v13, s[32:35], s44 offen lds
    s_add_u32 m0, m0, 1024
    s_add_u32 s44, s44, 8192
    s_waitcnt vmcnt(7)
    buffer_load_dwordx4 v13, s[32:35], s44 offen lds
    s_add_u32 m0, m0, 1024
    s_add_u32 s44, s44, 8192
    s_waitcnt vmcnt(7)
    buffer_load_dwordx4 v13, s[32:35], s44 offen lds
    s_add_u32 m0, m0, 1024
    s_add_u32 s44, s44, 8192
    s_waitcnt vmcnt(7)
    buffer_load_dwordx4 v13, s[32:35], s44 offen lds
    s_add_u32 m0, m0, 1024
    s_add_u32 s44, s44, 8192
    s_waitcnt vmcnt(7)
    buffer_load_dwordx4 v13, s[32:35], s44 offen lds
    s_waitcnt vmcnt(0)
    s_mov_b64 exec, 1
    ds_add_u32 v3, v14 offset:96
    s_mov_b64 exec, -1
L_no_qpoll:
    s_lshl_b32 s44, s40, 2
    s_lshr_b32 s54, 0x10103210, s44
    s_and_b32 s54, s54, 3
    s_lshl_b32 s54, s54, 15
    v_add_u32 v15, s44, v3
    v_mov_b32 v12, 0
    s_cmp_eq_u32 s40, 0
    s_cbranch_scc1 L_k_done
L_wf_31:
    ds_read_b32 v4, v3 offset:20
    s_waitcnt lgkmcnt(0)
    v_readfirstlane_b32 s43, v4
    s_cmp_ge_u32 s43, 2
    s_cbranch_scc1 L_wd_32
    s_sleep 1
    s_sub_u32 s42, s42, 1
    s_cbranch_scc0 L_wf_31
    s_endpgm
L_wd_32:
    s_cmp_lt_u32 s40, 4
    s_cbranch_scc1 L_kfree
    s_cmp_lt_u32 s40, 6
    s_cselect_b32 s44, 16, 8
    v_subrev_u32 v5, s44, v15
L_kw:
    ds_read_b32 v4, v5 offset:64
    s_waitcnt lgkmcnt(0)
    v_readfirstlane_b32 s43, v4
    s_cmp_ge_u32 s43, 1
    s_cbranch_scc1 L_kfree
    s_sleep 1
    s_sub_u32 s42, s42, 1
    s_cbranch_scc0 L_kw
    s_endpgm
L_kfree:
    s_setprio 2
    s_mov_b32 m0, s54
    s_mov_b32 s55, s47
    s_add_u32 s44, s40, s98
    s_lshl_b32 s44, s44, 3
    s_sub_u32 s44, s44, 6
L_wf_33:
    ds_read_b32 v4, v3 offset:16
    s_waitcnt lgkmcnt(0)
    v_readfirstlane_b32 s43, v4
    s_cmp_ge_u32 s43, s44
    s_cbranch_scc1 L_wd_34
    s_sleep 1
    s_sub_u32 s42, s42, 1
    s_cbranch_scc0 L_wf_33
    s_endpgm
L_wd_34:
    buffer_load_dwordx4 v16, s[20:23], s55 offen offset:0 nt lds
    buffer_load_dwordx4 v17, s[20:23], s55 offen offset:1024 nt lds
    buffer_load_dwordx4 v18, s[20:23], s55 offen offset:2048 nt lds
    buffer_load_dwordx4 v19, s[20:23], s55 offen offset:3072 nt lds
    s_add_u32 m0, m0, 4096
    s_add_u32 s55, s55, 4096
    s_add_u32 s44, s44, 1
L_wf_35:
    ds_read_b32 v4, v3 offset:16
    s_waitcnt lgkmcnt(0)
    v_readfirstlane_b32 s43, v4
    s_cmp_ge_u32 s43, s44
    s_cbranch_scc1 L_wd_36
    s_sleep 1
    s_sub_u32 s42, s42, 1
    s_cbranch_scc0 L_wf_35
    s_endpgm
L_wd_36:
    buffer_load_dwordx4 v16, s[20:23], s55 offen offset:0 nt lds
    buffer_load_dwordx4 v17, s[20:23], s55 offen offset:1024 nt lds
    buffer_load_dwordx4 v18, s[20:23], s55 offen offset:2048 nt lds
    buffer_load_dwordx4 v19, s[20:23], s55 offen offset:3072 nt lds
    s_add_u32 m0, m0, 4096
    s_add_u32 s55, s55, 4096
    s_add_u32 s44, s44, 1
L_wf_37:
    ds_read_b32 v4, v3 offset:16
    s_waitcnt lgkmcnt(0)
    v_readfirstlane_b32 s43, v4
    s_cmp_ge_u32 s43, s44
    s_cbranch_scc1 L_wd_38
    s_sleep 1
    s_sub_u32 s42, s42, 1
    s_cbranch_scc0 L_wf_37
    s_endpgm
L_wd_38:
    buffer_load_dwordx4 v16, s[20:23], s55 offen offset:0 nt lds
    buffer_load_dwordx4 v17, s[20:23], s55 offen offset:1024 nt lds
    buffer_load_dwordx4 v18, s[20:23], s55 offen offset:2048 nt lds
    buffer_load_dwordx4 v19, s[20:23], s55 offen offset:3072 nt lds
    s_add_u32 m0, m0, 4096
    s_add_u32 s55, s55, 4096
    s_add_u32 s44, s44, 1
L_wf_39:
    ds_read_b32 v4, v3 offset:16
    s_waitcnt lgkmcnt(0)
    v_readfirstlane_b32 s43, v4
    s_cmp_ge_u32 s43, s44
    s_cbranch_scc1 L_wd_40
    s_sleep 1
    s_sub_u32 s42, s42, 1
    s_cbranch_scc0 L_wf_39
    s_endpgm
L_wd_40:
    buffer_load_dwordx4 v16, s[20:23], s55 offen offset:0 nt lds
    buffer_load_dwordx4 v17, s[20:23], s55 offen offset:1024 nt lds
    buffer_load_dwordx4 v18, s[20:23], s55 offen offset:2048 nt lds
    buffer_load_dwordx4 v19, s[20:23], s55 offen offset:3072 nt lds
    s_add_u32 m0, m0, 4096
    s_add_u32 s55, s55, 4096
    s_add_u32 s44, s44, 1
L_wf_41:
    ds_read_b32 v4, v3 offset:16
    s_waitcnt lgkmcnt(0)
    v_readfirstlane_b32 s43, v4
    s_cmp_ge_u32 s43, s44
    s_cbranch_scc1 L_wd_42
    s_sleep 1
    s_sub_u32 s42, s42, 1
    s_cbranch_scc0 L_wf_41
    s_endpgm
L_wd_42:
    buffer_load_dwordx4 v16, s[20:23], s55 offen offset:0 nt lds
    buffer_load_dwordx4 v17, s[20:23], s55 offen offset:1024 nt lds
    buffer_load_dwordx4 v18, s[20:23], s55 offen offset:2048 nt lds
    buffer_load_dwordx4 v19, s[20:23], s55 offen offset:3072 nt lds
    s_add_u32 m0, m0, 4096
    s_add_u32 s55, s55, 4096
    s_add_u32 s44, s44, 1
L_wf_43:
    ds_read_b32 v4, v3 offset:16
    s_waitcnt lgkmcnt(0)
    v_readfirstlane_b32 s43, v4
    s_cmp_ge_u32 s43, s44
    s_cbranch_scc1 L_wd_44
    s_sleep 1
    s_sub_u32 s42, s42, 1
    s_cbranch_scc0 L_wf_43
    s_endpgm
L_wd_44:
    buffer_load_dwordx4 v16, s[20:23], s55 offen offset:0 nt lds
    buffer_load_dwordx4 v17, s[20:23], s55 offen offset:1024 nt lds
    buffer_load_dwordx4 v18, s[20:23], s55 offen offset:2048 nt lds
    buffer_load_dwordx4 v19, s[20:23], s55 offen offset:3072 nt lds
    s_add_u32 m0, m0, 4096
    s_add_u32 s55, s55, 4096
    s_add_u32 s44, s44, 1
L_wf_45:
    ds_read_b32 v4, v3 offset:16
    s_waitcnt lgkmcnt(0)
    v_readfirstlane_b32 s43, v4
    s_cmp_ge_u32 s43, s44
    s_cbranch_scc1 L_wd_46
    s_sleep 1
    s_sub_u32 s42, s42, 1
    s_cbranch_scc0 L_wf_45
    s_endpgm
L_wd_46:
    buffer_load_dwordx4 v16, s[20:23], s55 offen offset:0 nt lds
    buffer_load_dwordx4 v17, s[20:23], s55 offen offset:1024 nt lds
    buffer_load_dwordx4 v18, s[20:23], s55 offen offset:2048 nt lds
    buffer_load_dwordx4 v19, s[20:23], s55 offen offset:3072 nt lds
    s_add_u32 m0, m0, 4096
    s_add_u32 s55, s55, 4096
    s_waitcnt vmcnt(24)
    s_mov_b64 exec, 1
    ds_add_u32 v3, v14 offset:16
    s_mov_b64 exec, -1
    buffer_load_dwordx4 v16, s[20:23], s55 offen offset:0 nt lds
    buffer_load_dwordx4 v17, s[20:23], s55 offen offset:1024 nt lds
    buffer_load_dwordx4 v18, s[20:23], s55 offen offset:2048 nt lds
    buffer_load_dwordx4 v19, s[20:23], s55 offen offset:3072 nt lds
    ds_read_b32 v4, v3 offset:4
    v_mov_b32 v12, 1
    s_waitcnt lgkmcnt(0)
    v_readfirstlane_b32 s43, v4
    s_cmp_ge_u32 s43, 2
    s_cbranch_scc1 L_k_done
    v_mov_b32 v12, 0
    s_waitcnt vmcnt(24)
    s_mov_b64 exec, 1
    ds_add_u32 v3, v14 offset:16
    s_mov_b64 exec, -1
    s_waitcnt vmcnt(20)
    s_mov_b64 exec, 1
    ds_add_u32 v3, v14 offset:16
    s_mov_b64 exec, -1
    s_waitcnt vmcnt(16)
    s_mov_b64 exec, 1
    ds_add_u32 v3, v14 offset:16
    s_mov_b64 exec, -1
    s_waitcnt vmcnt(12)
    s_mov_b64 exec, 1
    ds_add_u32 v3, v14 offset:16
    s_mov_b64 exec, -1
    s_waitcnt vmcnt(8)
    s_mov_b64 exec, 1
    ds_add_u32 v3, v14 offset:16
    s_mov_b64 exec, -1
    s_waitcnt vmcnt(4)
    s_mov_b64 exec, 1
    ds_add_u32 v3, v14 offset:16
    s_mov_b64 exec, -1
    s_waitcnt vmcnt(0)
    s_mov_b64 exec, 1
    ds_add_u32 v3, v14 offset:16
    s_mov_b64 exec, -1
L_k_done:
    v_and_b32 v5, 3, v1
    v_bfe_u32 v6, v1, 2, 2
    v_lshl_add_u32 v5, v5, 2, v6
    v_lshrrev_b32 v6, 4, v1
    v_and_b32 v7, 15, v1
    v_xor_b32 v6, v6, v7
    v_lshlrev_b32 v6, 4, v6
    v_lshl_add_u32 v5, v5, 8, v6
    v_add_u32 v8, s54, v5
    v_xor_b32 v9, 64, v8
    v_xor_b32 v10, 128, v8
    v_xor_b32 v11, 192, v8
L_wf_47:
    ds_read_b32 v4, v3 offset:4
    s_waitcnt lgkmcnt(0)
    v_readfirstlane_b32 s43, v4
    s_cmp_ge_u32 s43, 2
    s_cbranch_scc1 L_wd_48
    s_sleep 1
    s_sub_u32 s42, s42, 1
    s_cbranch_scc0 L_wf_47
    s_endpgm
L_wd_48:
    v_add_u32 v5, 131072, v2
    ds_read_b128 v[32:35], v5 offset:0
    ds_read_b128 v[36:39], v5 offset:1024
    ds_read_b128 v[40:43], v5 offset:2048
    ds_read_b128 v[44:47], v5 offset:3072
    ds_read_b128 v[48:51], v5 offset:4096
    ds_read_b128 v[52:55], v5 offset:5120
    ds_read_b128 v[56:59], v5 offset:6144
    ds_read_b128 v[60:63], v5 offset:7168
    s_waitcnt vmcnt(28)
    ds_read_b128 v[16:19], v8
    ds_read_b128 v[20:23], v9
    ds_read_b128 v[24:27], v10
    ds_read_b128 v[28:31], v11
    s_waitcnt vmcnt(24)
    s_mov_b64 exec, 1
    ds_add_u32 v3, v12 offset:16
    s_mov_b64 exec, -1
    s_waitcnt lgkmcnt(4)
    v_mfma_f32_16x16x32_bf16 v[64:67], v[16:19], v[32:35], 0
    v_mfma_f32_16x16x32_bf16 v[72:75], v[16:19], v[48:51], 0
    ds_read_b128 v[16:19], v8 offset:4096
    s_waitcnt lgkmcnt(4)
    v_mfma_f32_16x16x32_bf16 v[64:67], v[20:23], v[36:39], v[64:67]
    v_mfma_f32_16x16x32_bf16 v[72:75], v[20:23], v[52:55], v[72:75]
    ds_read_b128 v[20:23], v9 offset:4096
    s_waitcnt lgkmcnt(4)
    v_mfma_f32_16x16x32_bf16 v[64:67], v[24:27], v[40:43], v[64:67]
    v_mfma_f32_16x16x32_bf16 v[72:75], v[24:27], v[56:59], v[72:75]
    ds_read_b128 v[24:27], v10 offset:4096
    s_waitcnt lgkmcnt(4)
    v_mfma_f32_16x16x32_bf16 v[64:67], v[28:31], v[44:47], v[64:67]
    v_mfma_f32_16x16x32_bf16 v[72:75], v[28:31], v[60:63], v[72:75]
    ds_read_b128 v[28:31], v11 offset:4096
    s_waitcnt vmcnt(20)
    s_mov_b64 exec, 1
    ds_add_u32 v3, v12 offset:16
    s_mov_b64 exec, -1
    s_waitcnt lgkmcnt(4)
    v_mfma_f32_16x16x32_bf16 v[68:71], v[16:19], v[32:35], 0
    v_mfma_f32_16x16x32_bf16 v[76:79], v[16:19], v[48:51], 0
    ds_read_b128 v[16:19], v8 offset:8192
    s_waitcnt lgkmcnt(4)
    v_mfma_f32_16x16x32_bf16 v[68:71], v[20:23], v[36:39], v[68:71]
    v_mfma_f32_16x16x32_bf16 v[76:79], v[20:23], v[52:55], v[76:79]
    ds_read_b128 v[20:23], v9 offset:8192
    s_waitcnt lgkmcnt(4)
    v_mfma_f32_16x16x32_bf16 v[68:71], v[24:27], v[40:43], v[68:71]
    v_mfma_f32_16x16x32_bf16 v[76:79], v[24:27], v[56:59], v[76:79]
    ds_read_b128 v[24:27], v10 offset:8192
    s_waitcnt lgkmcnt(4)
    v_mfma_f32_16x16x32_bf16 v[68:71], v[28:31], v[44:47], v[68:71]
    v_mfma_f32_16x16x32_bf16 v[76:79], v[28:31], v[60:63], v[76:79]
    ds_read_b128 v[28:31], v11 offset:8192
    s_waitcnt vmcnt(16)
    s_mov_b64 exec, 1
    ds_add_u32 v3, v12 offset:16
    s_mov_b64 exec, -1
    s_waitcnt lgkmcnt(4)
    v_mfma_f32_16x16x32_bf16 v[80:83], v[16:19], v[32:35], 0
    v_mfma_f32_16x16x32_bf16 v[88:91], v[16:19], v[48:51], 0
    ds_read_b128 v[16:19], v8 offset:12288
    s_waitcnt lgkmcnt(4)
    v_mfma_f32_16x16x32_bf16 v[80:83], v[20:23], v[36:39], v[80:83]
    v_mfma_f32_16x16x32_bf16 v[88:91], v[20:23], v[52:55], v[88:91]
    ds_read_b128 v[20:23], v9 offset:12288
    s_waitcnt lgkmcnt(4)
    v_mfma_f32_16x16x32_bf16 v[80:83], v[24:27], v[40:43], v[80:83]
    v_mfma_f32_16x16x32_bf16 v[88:91], v[24:27], v[56:59], v[88:91]
    ds_read_b128 v[24:27], v10 offset:12288
    s_waitcnt lgkmcnt(4)
    v_mfma_f32_16x16x32_bf16 v[80:83], v[28:31], v[44:47], v[80:83]
    v_mfma_f32_16x16x32_bf16 v[88:91], v[28:31], v[60:63], v[88:91]
    ds_read_b128 v[28:31], v11 offset:12288
    s_waitcnt vmcnt(12)
    s_mov_b64 exec, 1
    ds_add_u32 v3, v12 offset:16
    s_mov_b64 exec, -1
    s_waitcnt lgkmcnt(4)
    v_mfma_f32_16x16x32_bf16 v[84:87], v[16:19], v[32:35], 0
    v_mfma_f32_16x16x32_bf16 v[92:95], v[16:19], v[48:51], 0
    ds_read_b128 v[16:19], v8 offset:16384
    s_waitcnt lgkmcnt(4)
    v_mfma_f32_16x16x32_bf16 v[84:87], v[20:23], v[36:39], v[84:87]
    v_mfma_f32_16x16x32_bf16 v[92:95], v[20:23], v[52:55], v[92:95]
    ds_read_b128 v[20:23], v9 offset:16384
    s_waitcnt lgkmcnt(4)
    v_mfma_f32_16x16x32_bf16 v[84:87], v[24:27], v[40:43], v[84:87]
    v_mfma_f32_16x16x32_bf16 v[92:95], v[24:27], v[56:59], v[92:95]
    ds_read_b128 v[24:27], v10 offset:16384
    s_waitcnt lgkmcnt(4)
    v_mfma_f32_16x16x32_bf16 v[84:87], v[28:31], v[44:47], v[84:87]
    v_mfma_f32_16x16x32_bf16 v[92:95], v[28:31], v[60:63], v[92:95]
    ds_read_b128 v[28:31], v11 offset:16384
    s_waitcnt vmcnt(8)
    s_mov_b64 exec, 1
    ds_add_u32 v3, v12 offset:16
    s_mov_b64 exec, -1
    s_waitcnt lgkmcnt(4)
    v_mfma_f32_16x16x32_bf16 v[96:99], v[16:19], v[32:35], 0
    v_mfma_f32_16x16x32_bf16 v[104:107], v[16:19], v[48:51], 0
    ds_read_b128 v[16:19], v8 offset:20480
    s_waitcnt lgkmcnt(4)
    v_mfma_f32_16x16x32_bf16 v[96:99], v[20:23], v[36:39], v[96:99]
    v_mfma_f32_16x16x32_bf16 v[104:107], v[20:23], v[52:55], v[104:107]
    ds_read_b128 v[20:23], v9 offset:20480
    s_waitcnt lgkmcnt(4)
    v_mfma_f32_16x16x32_bf16 v[96:99], v[24:27], v[40:43], v[96:99]
    v_mfma_f32_16x16x32_bf16 v[104:107], v[24:27], v[56:59], v[104:107]
    ds_read_b128 v[24:27], v10 offset:20480
    s_waitcnt lgkmcnt(4)
    v_mfma_f32_16x16x32_bf16 v[96:99], v[28:31], v[44:47], v[96:99]
    v_mfma_f32_16x16x32_bf16 v[104:107], v[28:31], v[60:63], v[104:107]
    ds_read_b128 v[28:31], v11 offset:20480
    s_waitcnt vmcnt(4)
    s_mov_b64 exec, 1
    ds_add_u32 v3, v12 offset:16
    s_mov_b64 exec, -1
    s_waitcnt lgkmcnt(4)
    v_mfma_f32_16x16x32_bf16 v[100:103], v[16:19], v[32:35], 0
    v_mfma_f32_16x16x32_bf16 v[108:111], v[16:19], v[48:51], 0
    ds_read_b128 v[16:19], v8 offset:24576
    s_waitcnt lgkmcnt(4)
    v_mfma_f32_16x16x32_bf16 v[100:103], v[20:23], v[36:39], v[100:103]
    v_mfma_f32_16x16x32_bf16 v[108:111], v[20:23], v[52:55], v[108:111]
    ds_read_b128 v[20:23], v9 offset:24576
    s_waitcnt lgkmcnt(4)
    v_mfma_f32_16x16x32_bf16 v[100:103], v[24:27], v[40:43], v[100:103]
    v_mfma_f32_16x16x32_bf16 v[108:111], v[24:27], v[56:59], v[108:111]
    ds_read_b128 v[24:27], v10 offset:24576
    s_waitcnt lgkmcnt(4)
    v_mfma_f32_16x16x32_bf16 v[100:103], v[28:31], v[44:47], v[100:103]
    v_mfma_f32_16x16x32_bf16 v[108:111], v[28:31], v[60:63], v[108:111]
    ds_read_b128 v[28:31], v11 offset:24576
    s_waitcnt vmcnt(0)
    s_mov_b64 exec, 1
    ds_add_u32 v3, v12 offset:16
    s_mov_b64 exec, -1
    s_waitcnt lgkmcnt(4)
    v_mfma_f32_16x16x32_bf16 v[112:115], v[16:19], v[32:35], 0
    v_mfma_f32_16x16x32_bf16 v[120:123], v[16:19], v[48:51], 0
    ds_read_b128 v[16:19], v8 offset:28672
    s_waitcnt lgkmcnt(4)
    v_mfma_f32_16x16x32_bf16 v[112:115], v[20:23], v[36:39], v[112:115]
    v_mfma_f32_16x16x32_bf16 v[120:123], v[20:23], v[52:55], v[120:123]
    ds_read_b128 v[20:23], v9 offset:28672
    s_waitcnt lgkmcnt(4)
    v_mfma_f32_16x16x32_bf16 v[112:115], v[24:27], v[40:43], v[112:115]
    v_mfma_f32_16x16x32_bf16 v[120:123], v[24:27], v[56:59], v[120:123]
    ds_read_b128 v[24:27], v10 offset:28672
    s_waitcnt lgkmcnt(4)
    v_mfma_f32_16x16x32_bf16 v[112:115], v[28:31], v[44:47], v[112:115]
    v_mfma_f32_16x16x32_bf16 v[120:123], v[28:31], v[60:63], v[120:123]
    ds_read_b128 v[28:31], v11 offset:28672
    s_waitcnt lgkmcnt(3)
    v_mfma_f32_16x16x32_bf16 v[116:119], v[16:19], v[32:35], 0
    v_mfma_f32_16x16x32_bf16 v[124:127], v[16:19], v[48:51], 0
    s_waitcnt lgkmcnt(2)
    v_mfma_f32_16x16x32_bf16 v[116:119], v[20:23], v[36:39], v[116:119]
    v_mfma_f32_16x16x32_bf16 v[124:127], v[20:23], v[52:55], v[124:127]
    s_waitcnt lgkmcnt(1)
    v_mfma_f32_16x16x32_bf16 v[116:119], v[24:27], v[40:43], v[116:119]
    v_mfma_f32_16x16x32_bf16 v[124:127], v[24:27], v[56:59], v[124:127]
    s_waitcnt lgkmcnt(0)
    s_mov_b64 exec, 1
    ds_add_u32 v15, v14 offset:64
    s_mov_b64 exec, -1
    v_mfma_f32_16x16x32_bf16 v[116:119], v[28:31], v[44:47], v[116:119]
    v_mfma_f32_16x16x32_bf16 v[124:127], v[28:31], v[60:63], v[124:127]
    s_setprio 0
    s_nop 1
    s_nop 4
    v_max3_f32 v8, v64, v65, v66
    v_max3_f32 v8, v8, v67, v68
    v_max3_f32 v8, v8, v69, v70
    v_max3_f32 v8, v8, v71, v80
    v_max3_f32 v8, v8, v81, v82
    v_max3_f32 v8, v8, v83, v84
    v_max3_f32 v8, v8, v85, v86
    v_max3_f32 v8, v8, v87, v96
    v_max3_f32 v8, v8, v97, v98
    v_max3_f32 v8, v8, v99, v100
    v_max3_f32 v8, v8, v101, v102
    v_max3_f32 v8, v8, v103, v112
    v_max3_f32 v8, v8, v113, v114
    v_max3_f32 v8, v8, v115, v116
    v_max3_f32 v8, v8, v117, v118
    v_max_f32 v8, v8, v119
    v_max3_f32 v9, v72, v73, v74
    v_max3_f32 v9, v9, v75, v76
    v_max3_f32 v9, v9, v77, v78
    v_max3_f32 v9, v9, v79, v88
    v_max3_f32 v9, v9, v89, v90
    v_max3_f32 v9, v9, v91, v92
    v_max3_f32 v9, v9, v93, v94
    v_max3_f32 v9, v9, v95, v104
    v_max3_f32 v9, v9, v105, v106
    v_max3_f32 v9, v9, v107, v108
    v_max3_f32 v9, v9, v109, v110
    v_max3_f32 v9, v9, v111, v120
    v_max3_f32 v9, v9, v121, v122
    v_max3_f32 v9, v9, v123, v124
    v_max3_f32 v9, v9, v125, v126
    v_max_f32 v9, v9, v127
    v_mov_b32 v5, v8
    v_mov_b32 v6, v9
    s_nop 1
    v_permlane32_swap_b32 v8, v5
    v_permlane32_swap_b32 v9, v6
    s_nop 0
    v_max_f32 v8, v8, v5
    v_max_f32 v9, v9, v6
    v_mov_b32 v5, v8
    v_mov_b32 v6, v9
    s_nop 1
    v_permlane16_swap_b32 v8, v5
    v_permlane16_swap_b32 v9, v6
    s_nop 0
    v_max_f32 v8, v8, v5
    v_max_f32 v9, v9, v6
    v_and_b32 v5, 16, v1
    v_cmp_ne_u32 s[100:101], 0, v5
    v_and_b32 v5, 31, v1
    v_lshl_add_u32 v15, v5, 2, v3
    v_cndmask_b32 v8, v8, v9, s[100:101]
    v_mul_f32 v8, s53, v8
    v_mov_b32 v12, v8
    s_cmp_eq_u32 s40, 0
    s_cbranch_scc1 L_m_first
L_wf_49:
    ds_read_b32 v4, v3 offset:24
    s_waitcnt lgkmcnt(0)
    v_readfirstlane_b32 s43, v4
    s_cmp_ge_u32 s43, s40
    s_cbranch_scc1 L_wd_50
    s_sleep 1
    s_sub_u32 s42, s42, 1
    s_cbranch_scc0 L_wf_49
    s_endpgm
L_wd_50:
    ds_read_b32 v12, v15 offset:2816
    s_waitcnt lgkmcnt(0)
    v_max_f32 v8, v8, v12
L_m_first:
    ds_write_b32 v15, v8 offset:2816
    s_mov_b64 exec, 1
    ds_add_u32 v3, v14 offset:24
    s_mov_b64 exec, -1
    v_sub_f32 v12, v12, v8
    v_mov_b32 v13, v8
    v_mov_b32 v9, v8
    v_exp_f32 v12, v12
    s_nop 0
    v_permlane16_swap_b32 v8, v9
    s_nop 0
    v_fma_f32 v64, v64, s53, -v8
    v_fma_f32 v65, v65, s53, -v8
    v_fma_f32 v66, v66, s53, -v8
    v_fma_f32 v67, v67, s53, -v8
    v_fma_f32 v68, v68, s53, -v8
    v_fma_f32 v69, v69, s53, -v8
    v_fma_f32 v70, v70, s53, -v8
    v_fma_f32 v71, v71, s53, -v8
    v_fma_f32 v72, v72, s53, -v9
    v_fma_f32 v73, v73, s53, -v9
    v_fma_f32 v74, v74, s53, -v9
    v_fma_f32 v75, v75, s53, -v9
    v_fma_f32 v76, v76, s53, -v9
    v_fma_f32 v77, v77, s53, -v9
    v_fma_f32 v78, v78, s53, -v9
    v_fma_f32 v79, v79, s53, -v9
    v_fma_f32 v80, v80, s53, -v8
    v_fma_f32 v81, v81, s53, -v8
    v_fma_f32 v82, v82, s53, -v8
    v_fma_f32 v83, v83, s53, -v8
    v_fma_f32 v84, v84, s53, -v8
    v_fma_f32 v85, v85, s53, -v8
    v_fma_f32 v86, v86, s53, -v8
    v_fma_f32 v87, v87, s53, -v8
    v_fma_f32 v88, v88, s53, -v9
    v_fma_f32 v89, v89, s53, -v9
    v_fma_f32 v90, v90, s53, -v9
    v_fma_f32 v91, v91, s53, -v9
    v_fma_f32 v92, v92, s53, -v9
    v_fma_f32 v93, v93, s53, -v9
    v_fma_f32 v94, v94, s53, -v9
    v_fma_f32 v95, v95, s53, -v9
    v_fma_f32 v96, v96, s53, -v8
    v_fma_f32 v97, v97, s53, -v8
    v_fma_f32 v98, v98, s53, -v8
    v_fma_f32 v99, v99, s53, -v8
    v_fma_f32 v100, v100, s53, -v8
    v_fma_f32 v101, v101, s53, -v8
    v_fma_f32 v102, v102, s53, -v8
    v_fma_f32 v103, v103, s53, -v8
    v_fma_f32 v104, v104, s53, -v9
    v_fma_f32 v105, v105, s53, -v9
    v_fma_f32 v106, v106, s53, -v9
    v_fma_f32 v107, v107, s53, -v9
    v_fma_f32 v108, v108, s53, -v9
    v_fma_f32 v109, v109, s53, -v9
    v_fma_f32 v110, v110, s53, -v9
    v_fma_f32 v111, v111, s53, -v9
    v_fma_f32 v112, v112, s53, -v8
    v_fma_f32 v113, v113, s53, -v8
    v_fma_f32 v114, v114, s53, -v8
    v_fma_f32 v115, v115, s53, -v8
    v_fma_f32 v116, v116, s53, -v8
    v_fma_f32 v117, v117, s53, -v8
    v_fma_f32 v118, v118, s53, -v8
    v_fma_f32 v119, v119, s53, -v8
    v_fma_f32 v120, v120, s53, -v9
    v_fma_f32 v121, v121, s53, -v9
    v_fma_f32 v122, v122, s53, -v9
    v_fma_f32 v123, v123, s53, -v9
    v_fma_f32 v124, v124, s53, -v9
    v_fma_f32 v125, v125, s53, -v9
    v_fma_f32 v126, v126, s53, -v9
    v_fma_f32 v127, v127, s53, -v9
    v_exp_f32 v64, v64
    v_exp_f32 v65, v65
    v_exp_f32 v66, v66
    v_exp_f32 v67, v67
    v_exp_f32 v68, v68
    v_exp_f32 v69, v69
    v_exp_f32 v70, v70
    v_exp_f32 v71, v71
    v_exp_f32 v72, v72
    v_exp_f32 v73, v73
    v_exp_f32 v74, v74
    v_exp_f32 v75, v75
    v_exp_f32 v76, v76
    v_exp_f32 v77, v77
    v_exp_f32 v78, v78
    v_exp_f32 v79, v79
    v_exp_f32 v80, v80
    v_exp_f32 v81, v81
    v_exp_f32 v82, v82
    v_exp_f32 v83, v83
    v_exp_f32 v84, v84
    v_exp_f32 v85, v85
    v_exp_f32 v86, v86
    v_exp_f32 v87, v87
    v_exp_f32 v88, v88
    v_exp_f32 v89, v89
    v_exp_f32 v90, v90
    v_exp_f32 v91, v91
    v_exp_f32 v92, v92
    v_exp_f32 v93, v93
    v_exp_f32 v94, v94
    v_exp_f32 v95, v95
    v_exp_f32 v96, v96
    v_exp_f32 v97, v97
    v_exp_f32 v98, v98
    v_exp_f32 v99, v99
    v_exp_f32 v100, v100
    v_exp_f32 v101, v101
    v_exp_f32 v102, v102
    v_exp_f32 v103, v103
    v_exp_f32 v104, v104
    v_exp_f32 v105, v105
    v_exp_f32 v106, v106
    v_exp_f32 v107, v107
    v_exp_f32 v108, v108
    v_exp_f32 v109, v109
    v_exp_f32 v110, v110
    v_exp_f32 v111, v111
    v_exp_f32 v112, v112
    v_exp_f32 v113, v113
    v_exp_f32 v114, v114
    v_exp_f32 v115, v115
    v_exp_f32 v116, v116
    v_exp_f32 v117, v117
    v_exp_f32 v118, v118
    v_exp_f32 v119, v119
    v_exp_f32 v120, v120
    v_exp_f32 v121, v121
    v_exp_f32 v122, v122
    v_exp_f32 v123, v123
    v_exp_f32 v124, v124
    v_exp_f32 v125, v125
    v_exp_f32 v126, v126
    v_exp_f32 v127, v127
    v_add_f32 v10, v64, v65
    v_add_f32 v10, v10, v66
    v_add_f32 v10, v10, v67
    v_add_f32 v10, v10, v68
    v_add_f32 v10, v10, v69
    v_add_f32 v10, v10, v70
    v_add_f32 v10, v10, v71
    v_add_f32 v10, v10, v80
    v_add_f32 v10, v10, v81
    v_add_f32 v10, v10, v82
    v_add_f32 v10, v10, v83
    v_add_f32 v10, v10, v84
    v_add_f32 v10, v10, v85
    v_add_f32 v10, v10, v86
    v_add_f32 v10, v10, v87
    v_add_f32 v10, v10, v96
    v_add_f32 v10, v10, v97
    v_add_f32 v10, v10, v98
    v_add_f32 v10, v10, v99
    v_add_f32 v10, v10, v100
    v_add_f32 v10, v10, v101
    v_add_f32 v10, v10, v102
    v_add_f32 v10, v10, v103
    v_add_f32 v10, v10, v112
    v_add_f32 v10, v10, v113
    v_add_f32 v10, v10, v114
    v_add_f32 v10, v10, v115
    v_add_f32 v10, v10, v116
    v_add_f32 v10, v10, v117
    v_add_f32 v10, v10, v118
    v_add_f32 v10, v10, v119
    v_add_f32 v11, v72, v73
    v_add_f32 v11, v11, v74
    v_add_f32 v11, v11, v75
    v_add_f32 v11, v11, v76
    v_add_f32 v11, v11, v77
    v_add_f32 v11, v11, v78
    v_add_f32 v11, v11, v79
    v_add_f32 v11, v11, v88
    v_add_f32 v11, v11, v89
    v_add_f32 v11, v11, v90
    v_add_f32 v11, v11, v91
    v_add_f32 v11, v11, v92
    v_add_f32 v11, v11, v93
    v_add_f32 v11, v11, v94
    v_add_f32 v11, v11, v95
    v_add_f32 v11, v11, v104
    v_add_f32 v11, v11, v105
    v_add_f32 v11, v11, v106
    v_add_f32 v11, v11, v107
    v_add_f32 v11, v11, v108
    v_add_f32 v11, v11, v109
    v_add_f32 v11, v11, v110
    v_add_f32 v11, v11, v111
    v_add_f32 v11, v11, v120
    v_add_f32 v11, v11, v121
    v_add_f32 v11, v11, v122
    v_add_f32 v11, v11, v123
    v_add_f32 v11, v11, v124
    v_add_f32 v11, v11, v125
    v_add_f32 v11, v11, v126
    v_add_f32 v11, v11, v127
    v_mov_b32 v5, v10
    v_mov_b32 v6, v11
    s_nop 1
    v_permlane32_swap_b32 v10, v5
    v_permlane32_swap_b32 v11, v6
    s_nop 0
    v_add_f32 v10, v10, v5
    v_add_f32 v11, v11, v6
    v_mov_b32 v5, v10
    v_mov_b32 v6, v11
    s_nop 1
    v_permlane16_swap_b32 v10, v5
    v_permlane16_swap_b32 v11, v6
    s_nop 0
    v_add_f32 v10, v10, v5
    v_add_f32 v11, v11, v6
    v_cndmask_b32 v10, v10, v11, s[100:101]
    s_cmp_eq_u32 s40, 0
    s_cbranch_scc1 L_l_first
L_wf_51:
    ds_read_b32 v4, v3 offset:8
    s_waitcnt lgkmcnt(0)
    v_readfirstlane_b32 s43, v4
    s_cmp_ge_u32 s43, s40
    s_cbranch_scc1 L_wd_52
    s_sleep 1
    s_sub_u32 s42, s42, 1
    s_cbranch_scc0 L_wf_51
    s_endpgm
L_wd_52:
    ds_read_b32 v5, v15 offset:3072
    s_waitcnt lgkmcnt(0)
    v_fmac_f32 v10, v5, v12
L_l_first:
    ds_write_b32 v15, v10 offset:3072
    s_mov_b64 exec, 1
    ds_add_u32 v3, v14 offset:8
    s_mov_b64 exec, -1
    s_cmp_lg_u32 s40, 7
    s_cbranch_scc1 L_pack
    v_rcp_f32 v5, v10
    v_log_f32 v10, v10
    v_mul_f32 v12, v12, v5
    v_mov_b32 v6, v5
    v_add_f32 v0, v10, v13
    s_nop 0
    v_permlane16_swap_b32 v5, v6
    s_nop 0
    v_mul_f32 v64, v5, v64
    v_mul_f32 v65, v5, v65
    v_mul_f32 v66, v5, v66
    v_mul_f32 v67, v5, v67
    v_mul_f32 v68, v5, v68
    v_mul_f32 v69, v5, v69
    v_mul_f32 v70, v5, v70
    v_mul_f32 v71, v5, v71
    v_mul_f32 v72, v6, v72
    v_mul_f32 v73, v6, v73
    v_mul_f32 v74, v6, v74
    v_mul_f32 v75, v6, v75
    v_mul_f32 v76, v6, v76
    v_mul_f32 v77, v6, v77
    v_mul_f32 v78, v6, v78
    v_mul_f32 v79, v6, v79
    v_mul_f32 v80, v5, v80
    v_mul_f32 v81, v5, v81
    v_mul_f32 v82, v5, v82
    v_mul_f32 v83, v5, v83
    v_mul_f32 v84, v5, v84
    v_mul_f32 v85, v5, v85
    v_mul_f32 v86, v5, v86
    v_mul_f32 v87, v5, v87
    v_mul_f32 v88, v6, v88
    v_mul_f32 v89, v6, v89
    v_mul_f32 v90, v6, v90
    v_mul_f32 v91, v6, v91
    v_mul_f32 v92, v6, v92
    v_mul_f32 v93, v6, v93
    v_mul_f32 v94, v6, v94
    v_mul_f32 v95, v6, v95
    v_mul_f32 v96, v5, v96
    v_mul_f32 v97, v5, v97
    v_mul_f32 v98, v5, v98
    v_mul_f32 v99, v5, v99
    v_mul_f32 v100, v5, v100
    v_mul_f32 v101, v5, v101
    v_mul_f32 v102, v5, v102
    v_mul_f32 v103, v5, v103
    v_mul_f32 v104, v6, v104
    v_mul_f32 v105, v6, v105
    v_mul_f32 v106, v6, v106
    v_mul_f32 v107, v6, v107
    v_mul_f32 v108, v6, v108
    v_mul_f32 v109, v6, v109
    v_mul_f32 v110, v6, v110
    v_mul_f32 v111, v6, v111
    v_mul_f32 v112, v5, v112
    v_mul_f32 v113, v5, v113
    v_mul_f32 v114, v5, v114
    v_mul_f32 v115, v5, v115
    v_mul_f32 v116, v5, v116
    v_mul_f32 v117, v5, v117
    v_mul_f32 v118, v5, v118
    v_mul_f32 v119, v5, v119
    v_mul_f32 v120, v6, v120
    v_mul_f32 v121, v6, v121
    v_mul_f32 v122, v6, v122
    v_mul_f32 v123, v6, v123
    v_mul_f32 v124, v6, v124
    v_mul_f32 v125, v6, v125
    v_mul_f32 v126, v6, v126
    v_mul_f32 v127, v6, v127
L_pack:
    v_cvt_pk_bf16_f32 v64, v64, v65
    v_cvt_pk_bf16_f32 v65, v66, v67
    v_cvt_pk_bf16_f32 v66, v68, v69
    v_cvt_pk_bf16_f32 v67, v70, v71
    v_cvt_pk_bf16_f32 v68, v72, v73
    v_cvt_pk_bf16_f32 v69, v74, v75
    v_cvt_pk_bf16_f32 v70, v76, v77
    v_cvt_pk_bf16_f32 v71, v78, v79
    v_cvt_pk_bf16_f32 v72, v80, v81
    v_cvt_pk_bf16_f32 v73, v82, v83
    v_cvt_pk_bf16_f32 v74, v84, v85
    v_cvt_pk_bf16_f32 v75, v86, v87
    v_cvt_pk_bf16_f32 v76, v88, v89
    v_cvt_pk_bf16_f32 v77, v90, v91
    v_cvt_pk_bf16_f32 v78, v92, v93
    v_cvt_pk_bf16_f32 v79, v94, v95
    v_cvt_pk_bf16_f32 v80, v96, v97
    v_cvt_pk_bf16_f32 v81, v98, v99
    v_cvt_pk_bf16_f32 v82, v100, v101
    v_cvt_pk_bf16_f32 v83, v102, v103
    v_cvt_pk_bf16_f32 v84, v104, v105
    v_cvt_pk_bf16_f32 v85, v106, v107
    v_cvt_pk_bf16_f32 v86, v108, v109
    v_cvt_pk_bf16_f32 v87, v110, v111
    v_cvt_pk_bf16_f32 v88, v112, v113
    v_cvt_pk_bf16_f32 v89, v114, v115
    v_cvt_pk_bf16_f32 v90, v116, v117
    v_cvt_pk_bf16_f32 v91, v118, v119
    v_cvt_pk_bf16_f32 v92, v120, v121
    v_cvt_pk_bf16_f32 v93, v122, v123
    v_cvt_pk_bf16_f32 v94, v124, v125
    v_cvt_pk_bf16_f32 v95, v126, v127
    v_mov_b32 v11, 0
    s_cmp_lt_u32 s40, s98
    s_cbranch_scc1 L_no_late_v
    v_mov_b32 v11, 1
    s_lshl_b32 s44, s40, 3
    s_cmp_ge_u32 s40, 6
    s_cselect_b32 s45, 64, 58
    s_add_u32 s44, s44, s45
    s_mov_b32 s55, s47
    s_setprio 2
    s_cmp_lt_u32 s40, 6
    s_cbranch_scc1 L_v_gated
L_wf_53:
    ds_read_b32 v4, v3 offset:0
    s_waitcnt lgkmcnt(0)
    v_readfirstlane_b32 s43, v4
    s_cmp_ge_u32 s43, s40
    s_cbranch_scc1 L_wd_54
    s_sleep 1
    s_sub_u32 s42, s42, 1
    s_cbranch_scc0 L_wf_53
    s_endpgm
L_wd_54:
    s_mov_b32 s44, 0
L_v_gated:
L_wf_55:
    ds_read_b32 v4, v3 offset:16
    s_waitcnt lgkmcnt(0)
    v_readfirstlane_b32 s43, v4
    s_cmp_ge_u32 s43, s44
    s_cbranch_scc1 L_wd_56
    s_sleep 1
    s_sub_u32 s42, s42, 1
    s_cbranch_scc0 L_wf_55
    s_endpgm
L_wd_56:
    buffer_load_dwordx4 v[128:131], v2, s[24:27], s55 offen offset:0 nt
    buffer_load_dwordx4 v[132:135], v2, s[24:27], s55 offen offset:1024 nt
    buffer_load_dwordx4 v[136:139], v2, s[24:27], s55 offen offset:2048 nt
    buffer_load_dwordx4 v[140:143], v2, s[24:27], s55 offen offset:3072 nt
    s_add_u32 s55, s55, 4096
    s_add_u32 s44, s44, 1
L_wf_57:
    ds_read_b32 v4, v3 offset:16
    s_waitcnt lgkmcnt(0)
    v_readfirstlane_b32 s43, v4
    s_cmp_ge_u32 s43, s44
    s_cbranch_scc1 L_wd_58
    s_sleep 1
    s_sub_u32 s42, s42, 1
    s_cbranch_scc0 L_wf_57
    s_endpgm
L_wd_58:
    buffer_load_dwordx4 v[144:147], v2, s[24:27], s55 offen offset:0 nt
    buffer_load_dwordx4 v[148:151], v2, s[24:27], s55 offen offset:1024 nt
    buffer_load_dwordx4 v[152:155], v2, s[24:27], s55 offen offset:2048 nt
    buffer_load_dwordx4 v[156:159], v2, s[24:27], s55 offen offset:3072 nt
    s_add_u32 s55, s55, 4096
    s_add_u32 s44, s44, 1
L_wf_59:
    ds_read_b32 v4, v3 offset:16
    s_waitcnt lgkmcnt(0)
    v_readfirstlane_b32 s43, v4
    s_cmp_ge_u32 s43, s44
    s_cbranch_scc1 L_wd_60
    s_sleep 1
    s_sub_u32 s42, s42, 1
    s_cbranch_scc0 L_wf_59
    s_endpgm
L_wd_60:
    buffer_load_dwordx4 v[160:163], v2, s[24:27], s55 offen offset:0 nt
    buffer_load_dwordx4 v[164:167], v2, s[24:27], s55 offen offset:1024 nt
    buffer_load_dwordx4 v[168:171], v2, s[24:27], s55 offen offset:2048 nt
    buffer_load_dwordx4 v[172:175], v2, s[24:27], s55 offen offset:3072 nt
    s_add_u32 s55, s55, 4096
    s_add_u32 s44, s44, 1
L_wf_61:
    ds_read_b32 v4, v3 offset:16
    s_waitcnt lgkmcnt(0)
    v_readfirstlane_b32 s43, v4
    s_cmp_ge_u32 s43, s44
    s_cbranch_scc1 L_wd_62
    s_sleep 1
    s_sub_u32 s42, s42, 1
    s_cbranch_scc0 L_wf_61
    s_endpgm
L_wd_62:
    buffer_load_dwordx4 v[176:179], v2, s[24:27], s55 offen offset:0 nt
    buffer_load_dwordx4 v[180:183], v2, s[24:27], s55 offen offset:1024 nt
    buffer_load_dwordx4 v[184:187], v2, s[24:27], s55 offen offset:2048 nt
    buffer_load_dwordx4 v[188:191], v2, s[24:27], s55 offen offset:3072 nt
    s_add_u32 s55, s55, 4096
    s_add_u32 s44, s44, 1
L_wf_63:
    ds_read_b32 v4, v3 offset:16
    s_waitcnt lgkmcnt(0)
    v_readfirstlane_b32 s43, v4
    s_cmp_ge_u32 s43, s44
    s_cbranch_scc1 L_wd_64
    s_sleep 1
    s_sub_u32 s42, s42, 1
    s_cbranch_scc0 L_wf_63
    s_endpgm
L_wd_64:
    buffer_load_dwordx4 v[192:195], v2, s[24:27], s55 offen offset:0 nt
    buffer_load_dwordx4 v[196:199], v2, s[24:27], s55 offen offset:1024 nt
    buffer_load_dwordx4 v[200:203], v2, s[24:27], s55 offen offset:2048 nt
    buffer_load_dwordx4 v[204:207], v2, s[24:27], s55 offen offset:3072 nt
    s_add_u32 s55, s55, 4096
    s_add_u32 s44, s44, 1
L_wf_65:
    ds_read_b32 v4, v3 offset:16
    s_waitcnt lgkmcnt(0)
    v_readfirstlane_b32 s43, v4
    s_cmp_ge_u32 s43, s44
    s_cbranch_scc1 L_wd_66
    s_sleep 1
    s_sub_u32 s42, s42, 1
    s_cbranch_scc0 L_wf_65
    s_endpgm
L_wd_66:
    buffer_load_dwordx4 v[208:211], v2, s[24:27], s55 offen offset:0 nt
    buffer_load_dwordx4 v[212:215], v2, s[24:27], s55 offen offset:1024 nt
    buffer_load_dwordx4 v[216:219], v2, s[24:27], s55 offen offset:2048 nt
    buffer_load_dwordx4 v[220:223], v2, s[24:27], s55 offen offset:3072 nt
    s_add_u32 s55, s55, 4096
    s_add_u32 s44, s44, 1
L_wf_67:
    ds_read_b32 v4, v3 offset:16
    s_waitcnt lgkmcnt(0)
    v_readfirstlane_b32 s43, v4
    s_cmp_ge_u32 s43, s44
    s_cbranch_scc1 L_wd_68
    s_sleep 1
    s_sub_u32 s42, s42, 1
    s_cbranch_scc0 L_wf_67
    s_endpgm
L_wd_68:
    buffer_load_dwordx4 v[224:227], v2, s[24:27], s55 offen offset:0 nt
    buffer_load_dwordx4 v[228:231], v2, s[24:27], s55 offen offset:1024 nt
    buffer_load_dwordx4 v[232:235], v2, s[24:27], s55 offen offset:2048 nt
    buffer_load_dwordx4 v[236:239], v2, s[24:27], s55 offen offset:3072 nt
    s_add_u32 s55, s55, 4096
    s_waitcnt vmcnt(24)
    s_mov_b64 exec, 1
    ds_add_u32 v3, v14 offset:16
    s_mov_b64 exec, -1
    buffer_load_dwordx4 v[240:243], v2, s[24:27], s55 offen offset:0 nt
    buffer_load_dwordx4 v[244:247], v2, s[24:27], s55 offen offset:1024 nt
    buffer_load_dwordx4 v[248:251], v2, s[24:27], s55 offen offset:2048 nt
    buffer_load_dwordx4 v[252:255], v2, s[24:27], s55 offen offset:3072 nt
    s_mov_b64 exec, 1
    ds_add_u32 v3, v14 offset:0
    s_mov_b64 exec, -1
L_no_late_v:
    v_add_u32 v9, 139264, v2
    s_cmp_lg_u32 s40, 7
    s_cbranch_scc1 L_nof
    s_mov_b64 exec, 1
    ds_add_u32 v3, v14 offset:28
    s_mov_b64 exec, -1
    s_setprio 3
L_nof:
    v_mov_b32 v13, v12
    s_nop 1
    v_permlane16_swap_b32 v12, v13
    s_waitcnt vmcnt(28)
    s_waitcnt vmcnt(24)
    s_mov_b64 exec, 1
    ds_add_u32 v3, v11 offset:16
    s_mov_b64 exec, -1
    v_perm_b32 v112, v132, v128, s51
    v_perm_b32 v113, v140, v136, s51
    v_perm_b32 v114, v148, v144, s51
    v_perm_b32 v115, v156, v152, s51
    v_perm_b32 v116, v132, v128, s52
    v_perm_b32 v117, v140, v136, s52
    v_perm_b32 v118, v148, v144, s52
    v_perm_b32 v119, v156, v152, s52
    v_mfma_f32_16x16x32_bf16 v[16:19], v[112:115], v[64:67], 0
    v_mfma_f32_16x16x32_bf16 v[20:23], v[112:115], v[68:71], 0
    v_perm_b32 v120, v133, v129, s51
    v_perm_b32 v121, v141, v137, s51
    v_perm_b32 v122, v149, v145, s51
    v_perm_b32 v123, v157, v153, s51
    v_mfma_f32_16x16x32_bf16 v[24:27], v[116:119], v[64:67], 0
    v_mfma_f32_16x16x32_bf16 v[28:31], v[116:119], v[68:71], 0
    v_perm_b32 v124, v133, v129, s52
    v_perm_b32 v125, v141, v137, s52
    v_perm_b32 v126, v149, v145, s52
    v_perm_b32 v127, v157, v153, s52
    v_mfma_f32_16x16x32_bf16 v[32:35], v[120:123], v[64:67], 0
    v_mfma_f32_16x16x32_bf16 v[36:39], v[120:123], v[68:71], 0
    v_perm_b32 v112, v134, v130, s51
    v_perm_b32 v113, v142, v138, s51
    v_perm_b32 v114, v150, v146, s51
    v_perm_b32 v115, v158, v154, s51
    v_mfma_f32_16x16x32_bf16 v[40:43], v[124:127], v[64:67], 0
    v_mfma_f32_16x16x32_bf16 v[44:47], v[124:127], v[68:71], 0
    v_perm_b32 v116, v134, v130, s52
    v_perm_b32 v117, v142, v138, s52
    v_perm_b32 v118, v150, v146, s52
    v_perm_b32 v119, v158, v154, s52
    v_mfma_f32_16x16x32_bf16 v[48:51], v[112:115], v[64:67], 0
    v_mfma_f32_16x16x32_bf16 v[52:55], v[112:115], v[68:71], 0
    v_perm_b32 v120, v135, v131, s51
    v_perm_b32 v121, v143, v139, s51
    v_perm_b32 v122, v151, v147, s51
    v_perm_b32 v123, v159, v155, s51
    v_mfma_f32_16x16x32_bf16 v[56:59], v[116:119], v[64:67], 0
    v_mfma_f32_16x16x32_bf16 v[60:63], v[116:119], v[68:71], 0
    v_perm_b32 v124, v135, v131, s52
    v_perm_b32 v125, v143, v139, s52
    v_perm_b32 v126, v151, v147, s52
    v_perm_b32 v127, v159, v155, s52
    v_mfma_f32_16x16x32_bf16 v[96:99], v[120:123], v[64:67], 0
    v_mfma_f32_16x16x32_bf16 v[100:103], v[120:123], v[68:71], 0
    v_mfma_f32_16x16x32_bf16 v[104:107], v[124:127], v[64:67], 0
    v_mfma_f32_16x16x32_bf16 v[108:111], v[124:127], v[68:71], 0
    s_waitcnt vmcnt(20)
    s_mov_b64 exec, 1
    ds_add_u32 v3, v11 offset:16
    s_mov_b64 exec, -1
    s_waitcnt vmcnt(16)
    s_mov_b64 exec, 1
    ds_add_u32 v3, v11 offset:16
    s_mov_b64 exec, -1
    v_perm_b32 v112, v164, v160, s51
    v_perm_b32 v113, v172, v168, s51
    v_perm_b32 v114, v180, v176, s51
    v_perm_b32 v115, v188, v184, s51
    v_perm_b32 v116, v164, v160, s52
    v_perm_b32 v117, v172, v168, s52
    v_perm_b32 v118, v180, v176, s52
    v_perm_b32 v119, v188, v184, s52
    v_mfma_f32_16x16x32_bf16 v[16:19], v[112:115], v[72:75], v[16:19]
    v_mfma_f32_16x16x32_bf16 v[20:23], v[112:115], v[76:79], v[20:23]
    v_perm_b32 v120, v165, v161, s51
    v_perm_b32 v121, v173, v169, s51
    v_perm_b32 v122, v181, v177, s51
    v_perm_b32 v123, v189, v185, s51
    v_mfma_f32_16x16x32_bf16 v[24:27], v[116:119], v[72:75], v[24:27]
    v_mfma_f32_16x16x32_bf16 v[28:31], v[116:119], v[76:79], v[28:31]
    v_perm_b32 v124, v165, v161, s52
    v_perm_b32 v125, v173, v169, s52
    v_perm_b32 v126, v181, v177, s52
    v_perm_b32 v127, v189, v185, s52
    v_mfma_f32_16x16x32_bf16 v[32:35], v[120:123], v[72:75], v[32:35]
    v_mfma_f32_16x16x32_bf16 v[36:39], v[120:123], v[76:79], v[36:39]
    v_perm_b32 v112, v166, v162, s51
    v_perm_b32 v113, v174, v170, s51
    v_perm_b32 v114, v182, v178, s51
    v_perm_b32 v115, v190, v186, s51
    v_mfma_f32_16x16x32_bf16 v[40:43], v[124:127], v[72:75], v[40:43]
    v_mfma_f32_16x16x32_bf16 v[44:47], v[124:127], v[76:79], v[44:47]
    v_perm_b32 v116, v166, v162, s52
    v_perm_b32 v117, v174, v170, s52
    v_perm_b32 v118, v182, v178, s52
    v_perm_b32 v119, v190, v186, s52
    v_mfma_f32_16x16x32_bf16 v[48:51], v[112:115], v[72:75], v[48:51]
    v_mfma_f32_16x16x32_bf16 v[52:55], v[112:115], v[76:79], v[52:55]
    v_perm_b32 v120, v167, v163, s51
    v_perm_b32 v121, v175, v171, s51
    v_perm_b32 v122, v183, v179, s51
    v_perm_b32 v123, v191, v187, s51
    v_mfma_f32_16x16x32_bf16 v[56:59], v[116:119], v[72:75], v[56:59]
    v_mfma_f32_16x16x32_bf16 v[60:63], v[116:119], v[76:79], v[60:63]
    v_perm_b32 v124, v167, v163, s52
    v_perm_b32 v125, v175, v171, s52
    v_perm_b32 v126, v183, v179, s52
    v_perm_b32 v127, v191, v187, s52
    v_mfma_f32_16x16x32_bf16 v[96:99], v[120:123], v[72:75], v[96:99]
    v_mfma_f32_16x16x32_bf16 v[100:103], v[120:123], v[76:79], v[100:103]
    v_mfma_f32_16x16x32_bf16 v[104:107], v[124:127], v[72:75], v[104:107]
    v_mfma_f32_16x16x32_bf16 v[108:111], v[124:127], v[76:79], v[108:111]
    s_waitcnt vmcnt(12)
    s_mov_b64 exec, 1
    ds_add_u32 v3, v11 offset:16
    s_mov_b64 exec, -1
    s_waitcnt vmcnt(8)
    s_mov_b64 exec, 1
    ds_add_u32 v3, v11 offset:16
    s_mov_b64 exec, -1
    v_perm_b32 v112, v196, v192, s51
    v_perm_b32 v113, v204, v200, s51
    v_perm_b32 v114, v212, v208, s51
    v_perm_b32 v115, v220, v216, s51
    v_perm_b32 v116, v196, v192, s52
    v_perm_b32 v117, v204, v200, s52
    v_perm_b32 v118, v212, v208, s52
    v_perm_b32 v119, v220, v216, s52
    v_mfma_f32_16x16x32_bf16 v[16:19], v[112:115], v[80:83], v[16:19]
    v_mfma_f32_16x16x32_bf16 v[20:23], v[112:115], v[84:87], v[20:23]
    v_perm_b32 v120, v197, v193, s51
    v_perm_b32 v121, v205, v201, s51
    v_perm_b32 v122, v213, v209, s51
    v_perm_b32 v123, v221, v217, s51
    v_mfma_f32_16x16x32_bf16 v[24:27], v[116:119], v[80:83], v[24:27]
    v_mfma_f32_16x16x32_bf16 v[28:31], v[116:119], v[84:87], v[28:31]
    v_perm_b32 v124, v197, v193, s52
    v_perm_b32 v125, v205, v201, s52
    v_perm_b32 v126, v213, v209, s52
    v_perm_b32 v127, v221, v217, s52
    v_mfma_f32_16x16x32_bf16 v[32:35], v[120:123], v[80:83], v[32:35]
    v_mfma_f32_16x16x32_bf16 v[36:39], v[120:123], v[84:87], v[36:39]
    v_perm_b32 v112, v198, v194, s51
    v_perm_b32 v113, v206, v202, s51
    v_perm_b32 v114, v214, v210, s51
    v_perm_b32 v115, v222, v218, s51
    v_mfma_f32_16x16x32_bf16 v[40:43], v[124:127], v[80:83], v[40:43]
    v_mfma_f32_16x16x32_bf16 v[44:47], v[124:127], v[84:87], v[44:47]
    v_perm_b32 v116, v198, v194, s52
    v_perm_b32 v117, v206, v202, s52
    v_perm_b32 v118, v214, v210, s52
    v_perm_b32 v119, v222, v218, s52
    v_mfma_f32_16x16x32_bf16 v[48:51], v[112:115], v[80:83], v[48:51]
    v_mfma_f32_16x16x32_bf16 v[52:55], v[112:115], v[84:87], v[52:55]
    v_perm_b32 v120, v199, v195, s51
    v_perm_b32 v121, v207, v203, s51
    v_perm_b32 v122, v215, v211, s51
    v_perm_b32 v123, v223, v219, s51
    v_mfma_f32_16x16x32_bf16 v[56:59], v[116:119], v[80:83], v[56:59]
    v_mfma_f32_16x16x32_bf16 v[60:63], v[116:119], v[84:87], v[60:63]
    v_perm_b32 v124, v199, v195, s52
    v_perm_b32 v125, v207, v203, s52
    v_perm_b32 v126, v215, v211, s52
    v_perm_b32 v127, v223, v219, s52
    v_mfma_f32_16x16x32_bf16 v[96:99], v[120:123], v[80:83], v[96:99]
    v_mfma_f32_16x16x32_bf16 v[100:103], v[120:123], v[84:87], v[100:103]
    v_mfma_f32_16x16x32_bf16 v[104:107], v[124:127], v[80:83], v[104:107]
    v_mfma_f32_16x16x32_bf16 v[108:111], v[124:127], v[84:87], v[108:111]
    s_mov_b32 s62, 1
    s_cmp_eq_u32 s40, 0
    s_cbranch_scc1 L_ch_got
L_wf_69:
    ds_read_b32 v4, v3 offset:12
    s_waitcnt lgkmcnt(0)
    v_readfirstlane_b32 s43, v4
    s_cmp_ge_u32 s43, s40
    s_cbranch_scc1 L_wd_70
    s_sleep 1
    s_sub_u32 s42, s42, 1
    s_cbranch_scc0 L_wf_69
    s_endpgm
L_wd_70:
    ds_read_b128 v[128:131], v9 offset:0
    ds_read_b128 v[132:135], v9 offset:1024
    ds_read_b128 v[136:139], v9 offset:2048
    ds_read_b128 v[140:143], v9 offset:3072
    ds_read_b128 v[144:147], v9 offset:4096
    ds_read_b128 v[148:151], v9 offset:5120
    ds_read_b128 v[152:155], v9 offset:6144
    ds_read_b128 v[156:159], v9 offset:7168
    ds_read_b128 v[160:163], v9 offset:8192
    ds_read_b128 v[164:167], v9 offset:9216
    ds_read_b128 v[168:171], v9 offset:10240
    ds_read_b128 v[172:175], v9 offset:11264
    ds_read_b128 v[176:179], v9 offset:12288
    ds_read_b128 v[180:183], v9 offset:13312
    ds_read_b128 v[184:187], v9 offset:14336
    s_waitcnt lgkmcnt(14)
    ds_read_b128 v[188:191], v9 offset:15360
    v_fmac_f32 v16, v12, v128
    v_fmac_f32 v17, v12, v129
    v_fmac_f32 v18, v12, v130
    v_fmac_f32 v19, v12, v131
    s_waitcnt lgkmcnt(14)
    v_fmac_f32 v20, v13, v132
    v_fmac_f32 v21, v13, v133
    v_fmac_f32 v22, v13, v134
    v_fmac_f32 v23, v13, v135
    s_waitcnt lgkmcnt(13)
    v_fmac_f32 v24, v12, v136
    v_fmac_f32 v25, v12, v137
    v_fmac_f32 v26, v12, v138
    v_fmac_f32 v27, v12, v139
    s_waitcnt lgkmcnt(12)
    v_fmac_f32 v28, v13, v140
    v_fmac_f32 v29, v13, v141
    v_fmac_f32 v30, v13, v142
    v_fmac_f32 v31, v13, v143
    s_waitcnt lgkmcnt(11)
    v_fmac_f32 v32, v12, v144
    v_fmac_f32 v33, v12, v145
    v_fmac_f32 v34, v12, v146
    v_fmac_f32 v35, v12, v147
    s_waitcnt lgkmcnt(10)
    v_fmac_f32 v36, v13, v148
    v_fmac_f32 v37, v13, v149
    v_fmac_f32 v38, v13, v150
    v_fmac_f32 v39, v13, v151
    s_waitcnt lgkmcnt(9)
    v_fmac_f32 v40, v12, v152
    v_fmac_f32 v41, v12, v153
    v_fmac_f32 v42, v12, v154
    v_fmac_f32 v43, v12, v155
    s_waitcnt lgkmcnt(8)
    v_fmac_f32 v44, v13, v156
    v_fmac_f32 v45, v13, v157
    v_fmac_f32 v46, v13, v158
    v_fmac_f32 v47, v13, v159
    s_waitcnt lgkmcnt(7)
    v_fmac_f32 v48, v12, v160
    v_fmac_f32 v49, v12, v161
    v_fmac_f32 v50, v12, v162
    v_fmac_f32 v51, v12, v163
    s_waitcnt lgkmcnt(6)
    v_fmac_f32 v52, v13, v164
    v_fmac_f32 v53, v13, v165
    v_fmac_f32 v54, v13, v166
    v_fmac_f32 v55, v13, v167
    s_waitcnt lgkmcnt(5)
    v_fmac_f32 v56, v12, v168
    v_fmac_f32 v57, v12, v169
    v_fmac_f32 v58, v12, v170
    v_fmac_f32 v59, v12, v171
    s_waitcnt lgkmcnt(4)
    v_fmac_f32 v60, v13, v172
    v_fmac_f32 v61, v13, v173
    v_fmac_f32 v62, v13, v174
    v_fmac_f32 v63, v13, v175
    s_waitcnt lgkmcnt(3)
    v_fmac_f32 v96, v12, v176
    v_fmac_f32 v97, v12, v177
    v_fmac_f32 v98, v12, v178
    v_fmac_f32 v99, v12, v179
    s_waitcnt lgkmcnt(2)
    v_fmac_f32 v100, v13, v180
    v_fmac_f32 v101, v13, v181
    v_fmac_f32 v102, v13, v182
    v_fmac_f32 v103, v13, v183
    s_waitcnt lgkmcnt(1)
    v_fmac_f32 v104, v12, v184
    v_fmac_f32 v105, v12, v185
    v_fmac_f32 v106, v12, v186
    v_fmac_f32 v107, v12, v187
    s_waitcnt lgkmcnt(0)
    v_fmac_f32 v108, v13, v188
    v_fmac_f32 v109, v13, v189
    v_fmac_f32 v110, v13, v190
    v_fmac_f32 v111, v13, v191
L_ch_got:
    v_mov_b32 v213, v0
    v_mov_b32 v7, v0
    v_mov_b32 v195, s41
    v_mov_b32 v199, s41
    v_mov_b32 v203, s41
    v_mov_b32 v207, s41
    v_mov_b32 v211, s41
    v_mov_b32 v215, s41
    v_mov_b32 v219, s41
    v_mov_b32 v223, s41
    v_permlane16_swap_b32 v213, v7
    s_waitcnt vmcnt(4)
    s_mov_b64 exec, 1
    ds_add_u32 v3, v11 offset:16
    s_mov_b64 exec, -1
    s_waitcnt vmcnt(0)
    s_mov_b64 exec, 1
    ds_add_u32 v3, v11 offset:16
    s_mov_b64 exec, -1
    v_perm_b32 v112, v228, v224, s51
    v_perm_b32 v113, v236, v232, s51
    v_perm_b32 v114, v244, v240, s51
    v_perm_b32 v115, v252, v248, s51
    v_perm_b32 v116, v228, v224, s52
    v_perm_b32 v117, v236, v232, s52
    v_perm_b32 v118, v244, v240, s52
    v_perm_b32 v119, v252, v248, s52
    v_mfma_f32_16x16x32_bf16 v[16:19], v[112:115], v[88:91], v[16:19]
    v_mfma_f32_16x16x32_bf16 v[20:23], v[112:115], v[92:95], v[20:23]
    v_perm_b32 v120, v229, v225, s51
    v_perm_b32 v121, v237, v233, s51
    v_perm_b32 v122, v245, v241, s51
    v_perm_b32 v123, v253, v249, s51
    v_mfma_f32_16x16x32_bf16 v[24:27], v[116:119], v[88:91], v[24:27]
    v_mfma_f32_16x16x32_bf16 v[28:31], v[116:119], v[92:95], v[28:31]
    v_perm_b32 v124, v229, v225, s52
    v_perm_b32 v125, v237, v233, s52
    v_perm_b32 v126, v245, v241, s52
    v_perm_b32 v127, v253, v249, s52
    v_mfma_f32_16x16x32_bf16 v[32:35], v[120:123], v[88:91], v[32:35]
    v_mfma_f32_16x16x32_bf16 v[36:39], v[120:123], v[92:95], v[36:39]
    v_perm_b32 v112, v230, v226, s51
    v_perm_b32 v113, v238, v234, s51
    v_perm_b32 v114, v246, v242, s51
    v_perm_b32 v115, v254, v250, s51
    v_mfma_f32_16x16x32_bf16 v[40:43], v[124:127], v[88:91], v[40:43]
    v_mfma_f32_16x16x32_bf16 v[44:47], v[124:127], v[92:95], v[44:47]
    v_perm_b32 v116, v230, v226, s52
    v_perm_b32 v117, v238, v234, s52
    v_perm_b32 v118, v246, v242, s52
    v_perm_b32 v119, v254, v250, s52
    v_mfma_f32_16x16x32_bf16 v[48:51], v[112:115], v[88:91], v[48:51]
    v_mfma_f32_16x16x32_bf16 v[52:55], v[112:115], v[92:95], v[52:55]
    v_perm_b32 v120, v231, v227, s51
    v_perm_b32 v121, v239, v235, s51
    v_perm_b32 v122, v247, v243, s51
    v_perm_b32 v123, v255, v251, s51
    v_mfma_f32_16x16x32_bf16 v[56:59], v[116:119], v[88:91], v[56:59]
    v_mfma_f32_16x16x32_bf16 v[60:63], v[116:119], v[92:95], v[60:63]
    v_perm_b32 v124, v231, v227, s52
    v_perm_b32 v125, v239, v235, s52
    v_perm_b32 v126, v247, v243, s52
    v_perm_b32 v127, v255, v251, s52
    v_mfma_f32_16x16x32_bf16 v[96:99], v[120:123], v[88:91], v[96:99]
    v_mfma_f32_16x16x32_bf16 v[100:103], v[120:123], v[92:95], v[100:103]
    v_mfma_f32_16x16x32_bf16 v[104:107], v[124:127], v[88:91], v[104:107]
    v_mfma_f32_16x16x32_bf16 v[108:111], v[124:127], v[92:95], v[108:111]
    s_cmp_eq_u32 s40, 7
    s_cbranch_scc1 L_publish
    ds_write_b128 v9, v[16:19] offset:0
    ds_write_b128 v9, v[20:23] offset:1024
    ds_write_b128 v9, v[24:27] offset:2048
    ds_write_b128 v9, v[28:31] offset:3072
    ds_write_b128 v9, v[32:35] offset:4096
    ds_write_b128 v9, v[36:39] offset:5120
    ds_write_b128 v9, v[40:43] offset:6144
    ds_write_b128 v9, v[44:47] offset:7168
    ds_write_b128 v9, v[48:51] offset:8192
    ds_write_b128 v9, v[52:55] offset:9216
    ds_write_b128 v9, v[56:59] offset:10240
    ds_write_b128 v9, v[60:63] offset:11264
    ds_write_b128 v9, v[96:99] offset:12288
    ds_write_b128 v9, v[100:103] offset:13312
    ds_write_b128 v9, v[104:107] offset:14336
    ds_write_b128 v9, v[108:111] offset:15360
    s_waitcnt lgkmcnt(0)
    s_mov_b64 exec, 1
    ds_add_u32 v3, v14 offset:12
    s_mov_b64 exec, -1
    s_setprio 0
    s_cmp_lg_u32 s40, 0
    s_cbranch_scc1 L_no_pair
    v_mov_b32 v35, s41
    s_cmp_lg_u32 s2, 0
    s_cbranch_scc1 L_no_ep
    v_mul_u32_u24 v5, 6144, v1
L_epoll:
    s_mov_b32 s44, 0x40000
    buffer_load_dword v16, v5, s[28:31], s44 offen offset:12 sc1
    s_mov_b32 s44, 0xa0000
    buffer_load_dword v17, v5, s[28:31], s44 offen offset:12 sc1
    s_mov_b32 s44, 0x100000
    buffer_load_dword v18, v5, s[28:31], s44 offen offset:12 sc1
    s_mov_b32 s44, 0x160000
    buffer_load_dword v19, v5, s[28:31], s44 offen offset:12 sc1
    s_waitcnt vmcnt(0)
    v_cmp_ne_u32 vcc, s41, v16
    s_mov_b64 s[60:61], vcc
    v_cmp_ne_u32 vcc, s41, v17
    s_or_b64 s[60:61], s[60:61], vcc
    v_cmp_ne_u32 vcc, s41, v18
    s_or_b64 s[60:61], s[60:61], vcc
    v_cmp_ne_u32 vcc, s41, v19
    s_or_b64 s[60:61], s[60:61], vcc
    s_cbranch_scc0 L_eok
    s_sleep 1
    s_sub_u32 s42, s42, 1
    s_cbranch_scc0 L_epoll
    s_endpgm
L_eok:
    s_mov_b64 exec, 1
    buffer_store_dword v35, v2, s[28:31], 0 offen offset:0 sc1
    s_mov_b64 exec, -1
L_no_ep:
L_no_pair:
    s_cmp_ge_u32 s40, 4
    s_cbranch_scc1 L_tail
    v_bfe_u32 v5, v1, 2, 2
    v_lshrrev_b32 v6, 4, v1
    v_bfe_u32 v7, v1, 2, 3
    s_lshl_b32 s44, s40, 1
    v_xor_b32 v7, s44, v7
    v_lshl_add_u32 v5, v6, 5, v5
    v_lshlrev_b32 v5, 8, v5
    v_lshl_add_u32 v5, v7, 5, v5
    v_and_b32 v6, 3, v1
    v_lshl_add_u32 v5, v6, 3, v5
    v_add_u32 v8, 0x10000, v5
    v_xor_b32 v9, 32, v8
    s_cmp_lt_u32 s40, 2
    s_cbranch_scc1 L_wo_fetch
L_wf_71:
    ds_read_b32 v4, v3 offset:96
    s_waitcnt lgkmcnt(0)
    v_readfirstlane_b32 s43, v4
    s_cmp_ge_u32 s43, 2
    s_cbranch_scc1 L_wd_72
    s_sleep 1
    s_sub_u32 s42, s42, 1
    s_cbranch_scc0 L_wf_71
    s_endpgm
L_wd_72:
    ds_read_b64_tr_b16 v[128:129], v8 offset:0
    ds_read_b64_tr_b16 v[130:131], v8 offset:1024
    ds_read_b64_tr_b16 v[132:133], v8 offset:2048
    ds_read_b64_tr_b16 v[134:135], v8 offset:3072
    ds_read_b64_tr_b16 v[136:137], v8 offset:4096
    ds_read_b64_tr_b16 v[138:139], v8 offset:5120
    ds_read_b64_tr_b16 v[140:141], v8 offset:6144
    ds_read_b64_tr_b16 v[142:143], v8 offset:7168
    ds_read_b64_tr_b16 v[192:193], v9 offset:0
    ds_read_b64_tr_b16 v[194:195], v9 offset:1024
    ds_read_b64_tr_b16 v[196:197], v9 offset:2048
    ds_read_b64_tr_b16 v[198:199], v9 offset:3072
    ds_read_b64_tr_b16 v[200:201], v9 offset:4096
    ds_read_b64_tr_b16 v[202:203], v9 offset:5120
    ds_read_b64_tr_b16 v[204:205], v9 offset:6144
    ds_read_b64_tr_b16 v[206:207], v9 offset:7168
    s_waitcnt lgkmcnt(0)
    s_mov_b64 exec, 1
    ds_add_u32 v3, v14 offset:112
    s_mov_b64 exec, -1
L_wf_73:
    ds_read_b32 v4, v3 offset:100
    s_waitcnt lgkmcnt(0)
    v_readfirstlane_b32 s43, v4
    s_cmp_ge_u32 s43, 2
    s_cbranch_scc1 L_wd_74
    s_sleep 1
    s_sub_u32 s42, s42, 1
    s_cbranch_scc0 L_wf_73
    s_endpgm
L_wd_74:
    ds_read_b64_tr_b16 v[144:145], v8 offset:32768
    ds_read_b64_tr_b16 v[146:147], v8 offset:33792
    ds_read_b64_tr_b16 v[148:149], v8 offset:34816
    ds_read_b64_tr_b16 v[150:151], v8 offset:35840
    ds_read_b64_tr_b16 v[152:153], v8 offset:36864
    ds_read_b64_tr_b16 v[154:155], v8 offset:37888
    ds_read_b64_tr_b16 v[156:157], v8 offset:38912
    ds_read_b64_tr_b16 v[158:159], v8 offset:39936
    ds_read_b64_tr_b16 v[208:209], v9 offset:32768
    ds_read_b64_tr_b16 v[210:211], v9 offset:33792
    ds_read_b64_tr_b16 v[212:213], v9 offset:34816
    ds_read_b64_tr_b16 v[214:215], v9 offset:35840
    ds_read_b64_tr_b16 v[216:217], v9 offset:36864
    ds_read_b64_tr_b16 v[218:219], v9 offset:37888
    ds_read_b64_tr_b16 v[220:221], v9 offset:38912
    ds_read_b64_tr_b16 v[222:223], v9 offset:39936
    s_waitcnt lgkmcnt(0)
    s_mov_b64 exec, 1
    ds_add_u32 v3, v14 offset:116
    s_mov_b64 exec, -1
    s_branch L_wo_rest
L_wo_fetch:
    v_lshrrev_b32 v5, 4, v1
    v_lshlrev_b32 v6, 5, v5
    v_and_b32 v7, 0xff, v2
    v_xor_b32 v6, v6, v7
    v_lshl_add_u32 v12, v5, 11, v6
    v_xor_b32 v13, 0x80, v12
    s_lshl_b32 s99, s48, 20
    s_and_b32 s44, s49, 7
    s_lshl_b32 s44, s44, 8
    s_add_u32 s99, s99, s44
    s_and_b32 s44, s40, 1
    s_lshl_b32 s44, s44, 17
    s_add_u32 s99, s99, s44
L_wf_75:
    ds_read_b32 v4, v3 offset:76
    s_waitcnt lgkmcnt(0)
    v_readfirstlane_b32 s43, v4
    s_cmp_ge_u32 s43, 1
    s_cbranch_scc1 L_wd_76
    s_sleep 1
    s_sub_u32 s42, s42, 1
    s_cbranch_scc0 L_wf_75
    s_endpgm
L_wd_76:
L_wf_77:
    ds_read_b32 v4, v3 offset:96
    s_waitcnt lgkmcnt(0)
    v_readfirstlane_b32 s43, v4
    s_cmp_ge_u32 s43, 2
    s_cbranch_scc1 L_wd_78
    s_sleep 1
    s_sub_u32 s42, s42, 1
    s_cbranch_scc0 L_wf_77
    s_endpgm
L_wd_78:
    s_and_b32 s44, s40, 1
    s_lshl_b32 s44, s44, 14
    s_add_u32 m0, s44, 98304
    s_add_u32 s44, s99, 262144
    s_waitcnt vmcnt(7)
    buffer_load_dwordx4 v12, s[32:35], s44 offen lds
    s_add_u32 m0, m0, 1024
    s_add_u32 s44, s44, 8192
    s_waitcnt vmcnt(7)
    buffer_load_dwordx4 v12, s[32:35], s44 offen lds
    s_add_u32 m0, m0, 1024
    s_add_u32 s44, s44, 8192
    s_waitcnt vmcnt(7)
    buffer_load_dwordx4 v12, s[32:35], s44 offen lds
    s_add_u32 m0, m0, 1024
    s_add_u32 s44, s44, 8192
    s_waitcnt vmcnt(7)
    buffer_load_dwordx4 v12, s[32:35], s44 offen lds
    s_add_u32 m0, m0, 1024
    s_add_u32 s44, s44, 8192
    s_waitcnt vmcnt(7)
    buffer_load_dwordx4 v12, s[32:35], s44 offen lds
    s_add_u32 m0, m0, 1024
    s_add_u32 s44, s44, 8192
    s_waitcnt vmcnt(7)
    buffer_load_dwordx4 v12, s[32:35], s44 offen lds
    s_add_u32 m0, m0, 1024
    s_add_u32 s44, s44, 8192
    s_waitcnt vmcnt(7)
    buffer_load_dwordx4 v12, s[32:35], s44 offen lds
    s_add_u32 m0, m0, 1024
    s_add_u32 s44, s44, 8192
    s_waitcnt vmcnt(7)
    buffer_load_dwordx4 v12, s[32:35], s44 offen lds
    s_add_u32 m0, m0, 1024
    s_add_u32 s44, s44, 8192
    s_waitcnt vmcnt(7)
    buffer_load_dwordx4 v13, s[32:35], s44 offen lds
    s_add_u32 m0, m0, 1024
    s_add_u32 s44, s44, 8192
    s_waitcnt vmcnt(7)
    buffer_load_dwordx4 v13, s[32:35], s44 offen lds
    s_add_u32 m0, m0, 1024
    s_add_u32 s44, s44, 8192
    s_waitcnt vmcnt(7)
    buffer_load_dwordx4 v13, s[32:35], s44 offen lds
    s_add_u32 m0, m0, 1024
    s_add_u32 s44, s44, 8192
    s_waitcnt vmcnt(7)
    buffer_load_dwordx4 v13, s[32:35], s44 offen lds
    s_add_u32 m0, m0, 1024
    s_add_u32 s44, s44, 8192
    s_waitcnt vmcnt(7)
    buffer_load_dwordx4 v13, s[32:35], s44 offen lds
    s_add_u32 m0, m0, 1024
    s_add_u32 s44, s44, 8192
    s_waitcnt vmcnt(7)
    buffer_load_dwordx4 v13, s[32:35], s44 offen lds
    s_add_u32 m0, m0, 1024
    s_add_u32 s44, s44, 8192
    s_waitcnt vmcnt(7)
    buffer_load_dwordx4 v13, s[32:35], s44 offen lds
    s_add_u32 m0, m0, 1024
    s_add_u32 s44, s44, 8192
    s_waitcnt vmcnt(7)
    buffer_load_dwordx4 v13, s[32:35], s44 offen lds
L_wf_79:
    ds_read_b32 v4, v3 offset:96
    s_waitcnt lgkmcnt(0)
    v_readfirstlane_b32 s43, v4
    s_cmp_ge_u32 s43, 2
    s_cbranch_scc1 L_wd_80
    s_sleep 1
    s_sub_u32 s42, s42, 1
    s_cbranch_scc0 L_wf_79
    s_endpgm
L_wd_80:
    ds_read_b64_tr_b16 v[128:129], v8 offset:0
    ds_read_b64_tr_b16 v[130:131], v8 offset:1024
    ds_read_b64_tr_b16 v[132:133], v8 offset:2048
    ds_read_b64_tr_b16 v[134:135], v8 offset:3072
    ds_read_b64_tr_b16 v[136:137], v8 offset:4096
    ds_read_b64_tr_b16 v[138:139], v8 offset:5120
    ds_read_b64_tr_b16 v[140:141], v8 offset:6144
    ds_read_b64_tr_b16 v[142:143], v8 offset:7168
    ds_read_b64_tr_b16 v[192:193], v9 offset:0
    ds_read_b64_tr_b16 v[194:195], v9 offset:1024
    ds_read_b64_tr_b16 v[196:197], v9 offset:2048
    ds_read_b64_tr_b16 v[198:199], v9 offset:3072
    ds_read_b64_tr_b16 v[200:201], v9 offset:4096
    ds_read_b64_tr_b16 v[202:203], v9 offset:5120
    ds_read_b64_tr_b16 v[204:205], v9 offset:6144
    ds_read_b64_tr_b16 v[206:207], v9 offset:7168
    s_waitcnt lgkmcnt(0)
    s_mov_b64 exec, 1
    ds_add_u32 v3, v14 offset:112
    s_mov_b64 exec, -1
L_wf_81:
    ds_read_b32 v4, v3 offset:112
    s_waitcnt lgkmcnt(0)
    v_readfirstlane_b32 s43, v4
    s_cmp_ge_u32 s43, 4
    s_cbranch_scc1 L_wd_82
    s_sleep 1
    s_sub_u32 s42, s42, 1
    s_cbranch_scc0 L_wf_81
    s_endpgm
L_wd_82:
L_wf_83:
    ds_read_b32 v4, v3 offset:16
    s_waitcnt lgkmcnt(0)
    v_readfirstlane_b32 s43, v4
    s_cmp_ge_u32 s43, 108
    s_cbranch_scc1 L_wd_84
    s_sleep 1
    s_sub_u32 s42, s42, 1
    s_cbranch_scc0 L_wf_83
    s_endpgm
L_wd_84:
    s_and_b32 s44, s40, 1
    s_lshl_b32 s44, s44, 14
    s_add_u32 m0, s44, 65536
    s_add_u32 s44, s99, 524288
    s_waitcnt vmcnt(7)
    buffer_load_dwordx4 v12, s[32:35], s44 offen lds
    s_add_u32 m0, m0, 1024
    s_add_u32 s44, s44, 8192
    s_waitcnt vmcnt(7)
    buffer_load_dwordx4 v12, s[32:35], s44 offen lds
    s_add_u32 m0, m0, 1024
    s_add_u32 s44, s44, 8192
    s_waitcnt vmcnt(7)
    buffer_load_dwordx4 v12, s[32:35], s44 offen lds
    s_add_u32 m0, m0, 1024
    s_add_u32 s44, s44, 8192
    s_waitcnt vmcnt(7)
    buffer_load_dwordx4 v12, s[32:35], s44 offen lds
    s_add_u32 m0, m0, 1024
    s_add_u32 s44, s44, 8192
    s_waitcnt vmcnt(7)
    buffer_load_dwordx4 v12, s[32:35], s44 offen lds
    s_add_u32 m0, m0, 1024
    s_add_u32 s44, s44, 8192
    s_waitcnt vmcnt(7)
    buffer_load_dwordx4 v12, s[32:35], s44 offen lds
    s_add_u32 m0, m0, 1024
    s_add_u32 s44, s44, 8192
    s_waitcnt vmcnt(7)
    buffer_load_dwordx4 v12, s[32:35], s44 offen lds
    s_add_u32 m0, m0, 1024
    s_add_u32 s44, s44, 8192
    s_waitcnt vmcnt(7)
    buffer_load_dwordx4 v12, s[32:35], s44 offen lds
    s_add_u32 m0, m0, 1024
    s_add_u32 s44, s44, 8192
    s_waitcnt vmcnt(7)
    buffer_load_dwordx4 v13, s[32:35], s44 offen lds
    s_add_u32 m0, m0, 1024
    s_add_u32 s44, s44, 8192
    s_waitcnt vmcnt(7)
    buffer_load_dwordx4 v13, s[32:35], s44 offen lds
    s_add_u32 m0, m0, 1024
    s_add_u32 s44, s44, 8192
    s_waitcnt vmcnt(7)
    buffer_load_dwordx4 v13, s[32:35], s44 offen lds
    s_add_u32 m0, m0, 1024
    s_add_u32 s44, s44, 8192
    s_waitcnt vmcnt(7)
    buffer_load_dwordx4 v13, s[32:35], s44 offen lds
    s_add_u32 m0, m0, 1024
    s_add_u32 s44, s44, 8192
    s_waitcnt vmcnt(7)
    buffer_load_dwordx4 v13, s[32:35], s44 offen lds
    s_add_u32 m0, m0, 1024
    s_add_u32 s44, s44, 8192
    s_waitcnt vmcnt(7)
    buffer_load_dwordx4 v13, s[32:35], s44 offen lds
    s_add_u32 m0, m0, 1024
    s_add_u32 s44, s44, 8192
    s_waitcnt vmcnt(7)
    buffer_load_dwordx4 v13, s[32:35], s44 offen lds
    s_add_u32 m0, m0, 1024
    s_add_u32 s44, s44, 8192
    s_waitcnt vmcnt(7)
    buffer_load_dwordx4 v13, s[32:35], s44 offen lds
    s_mov_b64 exec, 1
    ds_add_u32 v3, v14 offset:100
    s_mov_b64 exec, -1
L_wf_85:
    ds_read_b32 v4, v3 offset:100
    s_waitcnt lgkmcnt(0)
    v_readfirstlane_b32 s43, v4
    s_cmp_ge_u32 s43, 2
    s_cbranch_scc1 L_wd_86
    s_sleep 1
    s_sub_u32 s42, s42, 1
    s_cbranch_scc0 L_wf_85
    s_endpgm
L_wd_86:
    ds_read_b64_tr_b16 v[144:145], v8 offset:32768
    ds_read_b64_tr_b16 v[146:147], v8 offset:33792
    ds_read_b64_tr_b16 v[148:149], v8 offset:34816
    ds_read_b64_tr_b16 v[150:151], v8 offset:35840
    ds_read_b64_tr_b16 v[152:153], v8 offset:36864
    ds_read_b64_tr_b16 v[154:155], v8 offset:37888
    ds_read_b64_tr_b16 v[156:157], v8 offset:38912
    ds_read_b64_tr_b16 v[158:159], v8 offset:39936
    ds_read_b64_tr_b16 v[208:209], v9 offset:32768
    ds_read_b64_tr_b16 v[210:211], v9 offset:33792
    ds_read_b64_tr_b16 v[212:213], v9 offset:34816
    ds_read_b64_tr_b16 v[214:215], v9 offset:35840
    ds_read_b64_tr_b16 v[216:217], v9 offset:36864
    ds_read_b64_tr_b16 v[218:219], v9 offset:37888
    ds_read_b64_tr_b16 v[220:221], v9 offset:38912
    ds_read_b64_tr_b16 v[222:223], v9 offset:39936
    s_waitcnt lgkmcnt(0)
    s_mov_b64 exec, 1
    ds_add_u32 v3, v14 offset:116
    s_mov_b64 exec, -1
L_wf_87:
    ds_read_b32 v4, v3 offset:116
    s_waitcnt lgkmcnt(0)
    v_readfirstlane_b32 s43, v4
    s_cmp_ge_u32 s43, 4
    s_cbranch_scc1 L_wd_88
    s_sleep 1
    s_sub_u32 s42, s42, 1
    s_cbranch_scc0 L_wf_87
    s_endpgm
L_wd_88:
L_wf_89:
    ds_read_b32 v4, v3 offset:16
    s_waitcnt lgkmcnt(0)
    v_readfirstlane_b32 s43, v4
    s_cmp_ge_u32 s43, 112
    s_cbranch_scc1 L_wd_90
    s_sleep 1
    s_sub_u32 s42, s42, 1
    s_cbranch_scc0 L_wf_89
    s_endpgm
L_wd_90:
L_wf_91:
    ds_read_b32 v4, v3 offset:28
    s_waitcnt lgkmcnt(0)
    v_readfirstlane_b32 s43, v4
    s_cmp_ge_u32 s43, 1
    s_cbranch_scc1 L_wd_92
    s_sleep 1
    s_sub_u32 s42, s42, 1
    s_cbranch_scc0 L_wf_91
    s_endpgm
L_wd_92:
    s_and_b32 s44, s40, 1
    s_lshl_b32 s44, s44, 14
    s_add_u32 m0, s44, 98304
    s_add_u32 s44, s99, 786432
    s_waitcnt vmcnt(7)
    buffer_load_dwordx4 v12, s[32:35], s44 offen lds
    s_add_u32 m0, m0, 1024
    s_add_u32 s44, s44, 8192
    s_waitcnt vmcnt(7)
    buffer_load_dwordx4 v12, s[32:35], s44 offen lds
    s_add_u32 m0, m0, 1024
    s_add_u32 s44, s44, 8192
    s_waitcnt vmcnt(7)
    buffer_load_dwordx4 v12, s[32:35], s44 offen lds
    s_add_u32 m0, m0, 1024
    s_add_u32 s44, s44, 8192
    s_waitcnt vmcnt(7)
    buffer_load_dwordx4 v12, s[32:35], s44 offen lds
    s_add_u32 m0, m0, 1024
    s_add_u32 s44, s44, 8192
    s_waitcnt vmcnt(7)
    buffer_load_dwordx4 v12, s[32:35], s44 offen lds
    s_add_u32 m0, m0, 1024
    s_add_u32 s44, s44, 8192
    s_waitcnt vmcnt(7)
    buffer_load_dwordx4 v12, s[32:35], s44 offen lds
    s_add_u32 m0, m0, 1024
    s_add_u32 s44, s44, 8192
    s_waitcnt vmcnt(7)
    buffer_load_dwordx4 v12, s[32:35], s44 offen lds
    s_add_u32 m0, m0, 1024
    s_add_u32 s44, s44, 8192
    s_waitcnt vmcnt(7)
    buffer_load_dwordx4 v12, s[32:35], s44 offen lds
    s_add_u32 m0, m0, 1024
    s_add_u32 s44, s44, 8192
    s_waitcnt vmcnt(7)
    buffer_load_dwordx4 v13, s[32:35], s44 offen lds
    s_add_u32 m0, m0, 1024
    s_add_u32 s44, s44, 8192
    s_waitcnt vmcnt(7)
    buffer_load_dwordx4 v13, s[32:35], s44 offen lds
    s_add_u32 m0, m0, 1024
    s_add_u32 s44, s44, 8192
    s_waitcnt vmcnt(7)
    buffer_load_dwordx4 v13, s[32:35], s44 offen lds
    s_add_u32 m0, m0, 1024
    s_add_u32 s44, s44, 8192
    s_waitcnt vmcnt(7)
    buffer_load_dwordx4 v13, s[32:35], s44 offen lds
    s_add_u32 m0, m0, 1024
    s_add_u32 s44, s44, 8192
    s_waitcnt vmcnt(7)
    buffer_load_dwordx4 v13, s[32:35], s44 offen lds
    s_add_u32 m0, m0, 1024
    s_add_u32 s44, s44, 8192
    s_waitcnt vmcnt(7)
    buffer_load_dwordx4 v13, s[32:35], s44 offen lds
    s_add_u32 m0, m0, 1024
    s_add_u32 s44, s44, 8192
    s_waitcnt vmcnt(7)
    buffer_load_dwordx4 v13, s[32:35], s44 offen lds
    s_add_u32 m0, m0, 1024
    s_add_u32 s44, s44, 8192
    s_waitcnt vmcnt(7)
    buffer_load_dwordx4 v13, s[32:35], s44 offen lds
    s_mov_b64 exec, 1
    ds_add_u32 v3, v14 offset:104
    s_mov_b64 exec, -1
    s_waitcnt vmcnt(0)
    s_mov_b64 exec, 1
    ds_add_u32 v3, v14 offset:108
    s_mov_b64 exec, -1
L_wo_rest:
L_wf_93:
    ds_read_b32 v4, v3 offset:104
    s_waitcnt lgkmcnt(0)
    v_readfirstlane_b32 s43, v4
    s_cmp_ge_u32 s43, 2
    s_cbranch_scc1 L_wd_94
    s_sleep 1
    s_sub_u32 s42, s42, 1
    s_cbranch_scc0 L_wf_93
    s_endpgm
L_wd_94:
    ds_read_b64_tr_b16 v[160:161], v8 offset:0
    ds_read_b64_tr_b16 v[162:163], v8 offset:1024
    ds_read_b64_tr_b16 v[164:165], v8 offset:2048
    ds_read_b64_tr_b16 v[166:167], v8 offset:3072
    ds_read_b64_tr_b16 v[168:169], v8 offset:4096
    ds_read_b64_tr_b16 v[170:171], v8 offset:5120
    ds_read_b64_tr_b16 v[172:173], v8 offset:6144
    ds_read_b64_tr_b16 v[174:175], v8 offset:7168
    ds_read_b64_tr_b16 v[224:225], v9 offset:0
    ds_read_b64_tr_b16 v[226:227], v9 offset:1024
    ds_read_b64_tr_b16 v[228:229], v9 offset:2048
    ds_read_b64_tr_b16 v[230:231], v9 offset:3072
    ds_read_b64_tr_b16 v[232:233], v9 offset:4096
    ds_read_b64_tr_b16 v[234:235], v9 offset:5120
    ds_read_b64_tr_b16 v[236:237], v9 offset:6144
    ds_read_b64_tr_b16 v[238:239], v9 offset:7168
L_wf_95:
    ds_read_b32 v4, v3 offset:108
    s_waitcnt lgkmcnt(0)
    v_readfirstlane_b32 s43, v4
    s_cmp_ge_u32 s43, 2
    s_cbranch_scc1 L_wd_96
    s_sleep 1
    s_sub_u32 s42, s42, 1
    s_cbranch_scc0 L_wf_95
    s_endpgm
L_wd_96:
    ds_read_b64_tr_b16 v[176:177], v8 offset:32768
    ds_read_b64_tr_b16 v[178:179], v8 offset:33792
    ds_read_b64_tr_b16 v[180:181], v8 offset:34816
    ds_read_b64_tr_b16 v[182:183], v8 offset:35840
    ds_read_b64_tr_b16 v[184:185], v8 offset:36864
    ds_read_b64_tr_b16 v[186:187], v8 offset:37888
    ds_read_b64_tr_b16 v[188:189], v8 offset:38912
    ds_read_b64_tr_b16 v[190:191], v8 offset:39936
    ds_read_b64_tr_b16 v[240:241], v9 offset:32768
    ds_read_b64_tr_b16 v[242:243], v9 offset:33792
    ds_read_b64_tr_b16 v[244:245], v9 offset:34816
    ds_read_b64_tr_b16 v[246:247], v9 offset:35840
    ds_read_b64_tr_b16 v[248:249], v9 offset:36864
    ds_read_b64_tr_b16 v[250:251], v9 offset:37888
    ds_read_b64_tr_b16 v[252:253], v9 offset:38912
    ds_read_b64_tr_b16 v[254:255], v9 offset:39936
    s_branch L_tail
L_publish:
    v_mov_b32 v227, s41
    v_mov_b32 v231, s41
    v_mov_b32 v235, s41
    v_mov_b32 v239, s41
    v_mov_b32 v237, v7
    s_mul_i32 s44, s50, 12288
    s_add_u32 s44, s44, 0x200000
    s_add_u32 s45, s44, 4096
    s_add_u32 s46, s44, 8192
    v_cvt_pk_bf16_f32 v192, v16, v24
    v_cvt_pk_bf16_f32 v193, v32, v40
    v_cvt_pk_bf16_f32 v194, v48, v56
    buffer_store_dwordx4 v[192:195], v2, s[28:31], s44 offen offset:0 sc1
    v_cvt_pk_bf16_f32 v216, v20, v28
    v_cvt_pk_bf16_f32 v217, v36, v44
    v_cvt_pk_bf16_f32 v218, v52, v60
    buffer_store_dwordx4 v[216:219], v2, s[28:31], s45 offen offset:2048 sc1
    v_cvt_pk_bf16_f32 v196, v17, v25
    v_cvt_pk_bf16_f32 v197, v33, v41
    v_cvt_pk_bf16_f32 v198, v49, v57
    buffer_store_dwordx4 v[196:199], v2, s[28:31], s44 offen offset:1024 sc1
    v_cvt_pk_bf16_f32 v220, v21, v29
    v_cvt_pk_bf16_f32 v221, v37, v45
    v_cvt_pk_bf16_f32 v222, v53, v61
    buffer_store_dwordx4 v[220:223], v2, s[28:31], s45 offen offset:3072 sc1
    v_cvt_pk_bf16_f32 v200, v18, v26
    v_cvt_pk_bf16_f32 v201, v34, v42
    v_cvt_pk_bf16_f32 v202, v50, v58
    buffer_store_dwordx4 v[200:203], v2, s[28:31], s44 offen offset:2048 sc1
    v_cvt_pk_bf16_f32 v224, v22, v30
    v_cvt_pk_bf16_f32 v225, v38, v46
    v_cvt_pk_bf16_f32 v226, v54, v62
    buffer_store_dwordx4 v[224:227], v2, s[28:31], s46 offen offset:0 sc1
    v_cvt_pk_bf16_f32 v204, v19, v27
    v_cvt_pk_bf16_f32 v205, v35, v43
    v_cvt_pk_bf16_f32 v206, v51, v59
    buffer_store_dwordx4 v[204:207], v2, s[28:31], s44 offen offset:3072 sc1
    v_cvt_pk_bf16_f32 v228, v23, v31
    v_cvt_pk_bf16_f32 v229, v39, v47
    v_cvt_pk_bf16_f32 v230, v55, v63
    buffer_store_dwordx4 v[228:231], v2, s[28:31], s46 offen offset:1024 sc1
    v_cvt_pk_bf16_f32 v208, v96, v104
    v_cvt_pk_bf16_f32 v209, v97, v105
    v_cvt_pk_bf16_f32 v210, v98, v106
    v_cvt_pk_bf16_f32 v212, v99, v107
    buffer_store_dwordx4 v[208:211], v2, s[28:31], s45 offen offset:0 sc1
    buffer_store_dwordx4 v[212:215], v2, s[28:31], s45 offen offset:1024 sc1
    v_cvt_pk_bf16_f32 v232, v100, v108
    v_cvt_pk_bf16_f32 v233, v101, v109
    v_cvt_pk_bf16_f32 v234, v102, v110
    v_cvt_pk_bf16_f32 v236, v103, v111
    buffer_store_dwordx4 v[232:235], v2, s[28:31], s46 offen offset:2048 sc1
    buffer_store_dwordx4 v[236:239], v2, s[28:31], s46 offen offset:3072 sc1
    s_mov_b64 exec, 1
    ds_add_u32 v3, v14 offset:28
    s_mov_b64 exec, -1
    s_setprio 0
L_tail:
    v_bfe_u32 v6, v1, 2, 2
    v_and_b32 v5, 0x330, v2
    v_lshl_add_u32 v6, v6, 12, v5
    s_add_u32 s54, s40, s49
    s_and_b32 s54, s54, 7
    s_lshr_b32 s44, s54, 2
    s_lshl_b32 s44, s44, 14
    s_and_b32 s45, s54, 3
    s_lshl_b32 s45, s45, 6
    s_add_u32 s44, s44, s45
    v_add_u32 v11, s44, v6
    s_and_b32 s44, s49, 24
    s_add_u32 s44, s44, s54
    s_lshl_b32 s44, s44, 3
    s_and_b32 s45, s48, 6
    s_add_u32 s44, s44, s45
    s_and_b32 s58, s49, 24
    s_lshl_b32 s58, s58, 3
    s_add_u32 s58, s58, s45
    s_lshl_b32 s58, s58, 5
    s_add_u32 s58, s58, 0x30000
    s_mov_b32 s59, s54
    s_mul_i32 s44, s44, 12288
    s_and_b32 s45, s48, 1
    s_mul_i32 s45, s45, 6144
    s_add_u32 s44, s44, s45
    s_add_u32 s55, s44, 0x200000
    s_add_u32 s56, s55, 4096
    s_add_u32 s57, s55, 12288
    s_add_u32 s54, s55, 16384
    s_mov_b32 s46, 0xffff0000
    s_cmp_lt_u32 s40, 0
    s_cselect_b32 s44, 1, 2
L_wf_97:
    ds_read_b32 v4, v3 offset:28
    s_waitcnt lgkmcnt(0)
    v_readfirstlane_b32 s43, v4
    s_cmp_ge_u32 s43, s44
    s_cbranch_scc1 L_wd_98
    s_sleep 1
    s_sub_u32 s42, s42, 1
    s_cbranch_scc0 L_wf_97
    s_endpgm
L_wd_98:
    v_mov_b32 v6, s41
L_oprobe:
    buffer_load_dwordx4 v[16:19], v2, s[28:31], s55 offen offset:0 sc1
    buffer_load_dwordx4 v[40:43], v2, s[28:31], s57 offen offset:0 sc1
    s_waitcnt vmcnt(0)
    v_xor_b32 v13, v6, v19
    v_bitop3_b32 v13, v6, v43, v13 bitop3:0xbe
    v_cmp_ne_u32 vcc, 0, v13
    s_cbranch_vccnz L_oretry
    buffer_load_dwordx4 v[36:39], v2, s[28:31], s56 offen offset:1024 sc1
    buffer_load_dwordx4 v[60:63], v2, s[28:31], s54 offen offset:1024 sc1
    buffer_load_dwordx4 v[32:35], v2, s[28:31], s56 offen offset:0 sc1
    buffer_load_dwordx4 v[56:59], v2, s[28:31], s54 offen offset:0 sc1
    buffer_load_dwordx4 v[20:23], v2, s[28:31], s55 offen offset:1024 sc1
    buffer_load_dwordx4 v[44:47], v2, s[28:31], s57 offen offset:1024 sc1
    buffer_load_dwordx4 v[24:27], v2, s[28:31], s55 offen offset:2048 sc1
    buffer_load_dwordx4 v[48:51], v2, s[28:31], s57 offen offset:2048 sc1
    buffer_load_dwordx4 v[28:31], v2, s[28:31], s55 offen offset:3072 sc1
    buffer_load_dwordx4 v[52:55], v2, s[28:31], s57 offen offset:3072 sc1
    s_waitcnt vmcnt(8)
    v_sub_f32 v7, v61, v37
    v_exp_f32 v7, v7
    v_bitop3_b32 v13, v6, v39, v13 bitop3:0xbe
    v_bitop3_b32 v13, v6, v63, v13 bitop3:0xbe
    v_add_f32 v7, 1.0, v7
    v_rcp_f32 v7, v7
    v_lshlrev_b32 v80, 16, v16
    v_lshlrev_b32 v81, 16, v40
    v_lshlrev_b32 v82, 16, v17
    v_lshlrev_b32 v83, 16, v41
    v_lshlrev_b32 v84, 16, v18
    v_lshlrev_b32 v85, 16, v42
    v_lshlrev_b32 v86, 16, v36
    v_lshlrev_b32 v87, 16, v60
    v_and_b32 v16, s46, v16
    v_and_b32 v40, s46, v40
    v_and_b32 v17, s46, v17
    v_and_b32 v41, s46, v41
    v_and_b32 v18, s46, v18
    v_and_b32 v42, s46, v42
    v_and_b32 v36, s46, v36
    v_and_b32 v60, s46, v60
    v_sub_f32 v80, v80, v81
    v_sub_f32 v16, v16, v40
    v_sub_f32 v82, v82, v83
    v_sub_f32 v17, v17, v41
    v_sub_f32 v84, v84, v85
    v_sub_f32 v18, v18, v42
    v_sub_f32 v86, v86, v87
    v_sub_f32 v36, v36, v60
    v_fmac_f32 v81, v7, v80
    v_fmac_f32 v40, v7, v16
    v_fmac_f32 v83, v7, v82
    v_fmac_f32 v41, v7, v17
    v_fmac_f32 v85, v7, v84
    v_fmac_f32 v42, v7, v18
    v_fmac_f32 v87, v7, v86
    v_fmac_f32 v60, v7, v36
    v_cvt_pk_bf16_f32 v64, v81, v40
    v_cvt_pk_bf16_f32 v65, v83, v41
    v_cvt_pk_bf16_f32 v66, v85, v42
    v_cvt_pk_bf16_f32 v79, v87, v60
    s_waitcnt vmcnt(6)
    v_bitop3_b32 v13, v6, v35, v13 bitop3:0xbe
    v_bitop3_b32 v13, v6, v59, v13 bitop3:0xbe
    v_lshlrev_b32 v80, 16, v32
    v_lshlrev_b32 v81, 16, v56
    v_lshlrev_b32 v82, 16, v33
    v_lshlrev_b32 v83, 16, v57
    v_lshlrev_b32 v84, 16, v34
    v_lshlrev_b32 v85, 16, v58
    v_and_b32 v32, s46, v32
    v_and_b32 v56, s46, v56
    v_and_b32 v33, s46, v33
    v_and_b32 v57, s46, v57
    v_and_b32 v34, s46, v34
    v_and_b32 v58, s46, v58
    v_sub_f32 v80, v80, v81
    v_sub_f32 v32, v32, v56
    v_sub_f32 v82, v82, v83
    v_sub_f32 v33, v33, v57
    v_sub_f32 v84, v84, v85
    v_sub_f32 v34, v34, v58
    v_fmac_f32 v81, v7, v80
    v_fmac_f32 v56, v7, v32
    v_fmac_f32 v83, v7, v82
    v_fmac_f32 v57, v7, v33
    v_fmac_f32 v85, v7, v84
    v_fmac_f32 v58, v7, v34
    v_cvt_pk_bf16_f32 v67, v81, v56
    v_cvt_pk_bf16_f32 v71, v83, v57
    v_cvt_pk_bf16_f32 v75, v85, v58
    ds_write_b128 v11, v[64:67] offset:0
    s_waitcnt vmcnt(4)
    v_bitop3_b32 v13, v6, v23, v13 bitop3:0xbe
    v_bitop3_b32 v13, v6, v47, v13 bitop3:0xbe
    v_lshlrev_b32 v80, 16, v20
    v_lshlrev_b32 v81, 16, v44
    v_lshlrev_b32 v82, 16, v21
    v_lshlrev_b32 v83, 16, v45
    v_lshlrev_b32 v84, 16, v22
    v_lshlrev_b32 v85, 16, v46
    v_and_b32 v20, s46, v20
    v_and_b32 v44, s46, v44
    v_and_b32 v21, s46, v21
    v_and_b32 v45, s46, v45
    v_and_b32 v22, s46, v22
    v_and_b32 v46, s46, v46
    v_sub_f32 v80, v80, v81
    v_sub_f32 v20, v20, v44
    v_sub_f32 v82, v82, v83
    v_sub_f32 v21, v21, v45
    v_sub_f32 v84, v84, v85
    v_sub_f32 v22, v22, v46
    v_fmac_f32 v81, v7, v80
    v_fmac_f32 v44, v7, v20
    v_fmac_f32 v83, v7, v82
    v_fmac_f32 v45, v7, v21
    v_fmac_f32 v85, v7, v84
    v_fmac_f32 v46, v7, v22
    v_cvt_pk_bf16_f32 v68, v81, v44
    v_cvt_pk_bf16_f32 v69, v83, v45
    v_cvt_pk_bf16_f32 v70, v85, v46
    ds_write_b128 v11, v[68:71] offset:1024
    s_waitcnt vmcnt(2)
    v_bitop3_b32 v13, v6, v27, v13 bitop3:0xbe
    v_bitop3_b32 v13, v6, v51, v13 bitop3:0xbe
    v_lshlrev_b32 v80, 16, v24
    v_lshlrev_b32 v81, 16, v48
    v_lshlrev_b32 v82, 16, v25
    v_lshlrev_b32 v83, 16, v49
    v_lshlrev_b32 v84, 16, v26
    v_lshlrev_b32 v85, 16, v50
    v_and_b32 v24, s46, v24
    v_and_b32 v48, s46, v48
    v_and_b32 v25, s46, v25
    v_and_b32 v49, s46, v49
    v_and_b32 v26, s46, v26
    v_and_b32 v50, s46, v50
    v_sub_f32 v80, v80, v81
    v_sub_f32 v24, v24, v48
    v_sub_f32 v82, v82, v83
    v_sub_f32 v25, v25, v49
    v_sub_f32 v84, v84, v85
    v_sub_f32 v26, v26, v50
    v_fmac_f32 v81, v7, v80
    v_fmac_f32 v48, v7, v24
    v_fmac_f32 v83, v7, v82
    v_fmac_f32 v49, v7, v25
    v_fmac_f32 v85, v7, v84
    v_fmac_f32 v50, v7, v26
    v_cvt_pk_bf16_f32 v72, v81, v48
    v_cvt_pk_bf16_f32 v73, v83, v49
    v_cvt_pk_bf16_f32 v74, v85, v50
    ds_write_b128 v11, v[72:75] offset:2048
    s_waitcnt vmcnt(0)
    v_bitop3_b32 v13, v6, v31, v13 bitop3:0xbe
    v_bitop3_b32 v13, v6, v55, v13 bitop3:0xbe
    v_lshlrev_b32 v80, 16, v28
    v_lshlrev_b32 v81, 16, v52
    v_lshlrev_b32 v82, 16, v29
    v_lshlrev_b32 v83, 16, v53
    v_lshlrev_b32 v84, 16, v30
    v_lshlrev_b32 v85, 16, v54
    v_and_b32 v28, s46, v28
    v_and_b32 v52, s46, v52
    v_and_b32 v29, s46, v29
    v_and_b32 v53, s46, v53
    v_and_b32 v30, s46, v30
    v_and_b32 v54, s46, v54
    v_sub_f32 v80, v80, v81
    v_sub_f32 v28, v28, v52
    v_sub_f32 v82, v82, v83
    v_sub_f32 v29, v29, v53
    v_sub_f32 v84, v84, v85
    v_sub_f32 v30, v30, v54
    v_fmac_f32 v81, v7, v80
    v_fmac_f32 v52, v7, v28
    v_fmac_f32 v83, v7, v82
    v_fmac_f32 v53, v7, v29
    v_fmac_f32 v85, v7, v84
    v_fmac_f32 v54, v7, v30
    v_cvt_pk_bf16_f32 v76, v81, v52
    v_cvt_pk_bf16_f32 v77, v83, v53
    v_cvt_pk_bf16_f32 v78, v85, v54
    ds_write_b128 v11, v[76:79] offset:3072
    v_cmp_ne_u32 vcc, 0, v13
    s_cmp_lg_u64 vcc, 0
    s_cbranch_scc0 L_ook
L_oretry:
    s_waitcnt vmcnt(0)
    s_sleep 1
    s_sub_u32 s42, s42, 1
    s_cbranch_scc0 L_oprobe
    s_endpgm
L_ook:
    v_bfe_u32 v4, v1, 2, 2
    v_lshrrev_b32 v5, 4, v1
    v_and_b32 v6, 3, v1
    v_lshl_add_u32 v5, v5, 2, v6
    v_lshlrev_b32 v5, 4, v5
    v_lshl_add_u32 v8, v4, 8, v5
    s_lshl_b32 s55, s49, 17
    s_add_u32 s55, s55, 0x600000
    s_lshl_b32 s44, s48, 14
    s_lshl_b32 s45, s40, 11
    s_add_u32 s44, s44, s45
    s_add_u32 s44, s44, s55
    s_add_u32 s45, s44, 8192
    s_movk_i32 s46, 0xff
    v_mov_b32 v5, s41
    s_and_b32 s43, s59, 4
    v_add_u32 v4, s43, v3
    s_waitcnt lgkmcnt(0)
    s_mov_b64 exec, 1
    ds_add_u32 v4, v14 offset:40
    s_mov_b64 exec, -1
    s_cmp_ge_u32 s40, 4
    s_cbranch_scc1 L_reduce
L_msw:
    ds_read_b64 v[12:13], v3 offset:40
    s_waitcnt lgkmcnt(0)
    v_readfirstlane_b32 s43, v12
    v_readfirstlane_b32 s62, v13
    s_cmp_ge_u32 s43, 4
    s_cselect_b32 s63, 0, 1
    s_cbranch_scc1 L_msgo
    s_cmp_ge_u32 s62, 4
    s_cbranch_scc1 L_msgo
    s_sub_u32 s42, s42, 1
    s_cbranch_scc0 L_msw
    s_endpgm
L_msgo:
    s_lshl_b32 s43, s63, 14
    v_add_u32 v13, s43, v2
    ds_read_b128 v[16:19], v13 offset:0
    ds_read_b128 v[20:23], v13 offset:1024
    ds_read_b128 v[24:27], v13 offset:2048
    ds_read_b128 v[28:31], v13 offset:3072
    ds_read_b128 v[32:35], v13 offset:4096
    ds_read_b128 v[36:39], v13 offset:5120
    ds_read_b128 v[40:43], v13 offset:6144
    ds_read_b128 v[44:47], v13 offset:7168
    s_lshl_b32 s45, s63, 13
    s_add_u32 s45, s45, s44
    s_waitcnt lgkmcnt(7)
    v_mfma_f32_16x16x32_bf16 v[112:115], v[128:131], v[16:19], 0
    v_mfma_f32_16x16x32_bf16 v[116:119], v[192:195], v[16:19], 0
    ds_read_b128 v[16:19], v13 offset:8192
    s_waitcnt lgkmcnt(7)
    v_mfma_f32_16x16x32_bf16 v[112:115], v[132:135], v[20:23], v[112:115]
    v_mfma_f32_16x16x32_bf16 v[116:119], v[196:199], v[20:23], v[116:119]
    ds_read_b128 v[20:23], v13 offset:9216
    s_waitcnt lgkmcnt(7)
    v_mfma_f32_16x16x32_bf16 v[112:115], v[136:139], v[24:27], v[112:115]
    v_mfma_f32_16x16x32_bf16 v[116:119], v[200:203], v[24:27], v[116:119]
    ds_read_b128 v[24:27], v13 offset:10240
    s_waitcnt lgkmcnt(7)
    v_mfma_f32_16x16x32_bf16 v[112:115], v[140:143], v[28:31], v[112:115]
    v_mfma_f32_16x16x32_bf16 v[116:119], v[204:207], v[28:31], v[116:119]
    ds_read_b128 v[28:31], v13 offset:11264
    s_waitcnt lgkmcnt(7)
    v_mfma_f32_16x16x32_bf16 v[112:115], v[144:147], v[32:35], v[112:115]
    v_mfma_f32_16x16x32_bf16 v[116:119], v[208:211], v[32:35], v[116:119]
    ds_read_b128 v[32:35], v13 offset:12288
    s_waitcnt lgkmcnt(7)
    v_mfma_f32_16x16x32_bf16 v[112:115], v[148:151], v[36:39], v[112:115]
    v_mfma_f32_16x16x32_bf16 v[116:119], v[212:215], v[36:39], v[116:119]
    ds_read_b128 v[36:39], v13 offset:13312
    s_waitcnt lgkmcnt(7)
    v_mfma_f32_16x16x32_bf16 v[112:115], v[152:155], v[40:43], v[112:115]
    v_mfma_f32_16x16x32_bf16 v[116:119], v[216:219], v[40:43], v[116:119]
    ds_read_b128 v[40:43], v13 offset:14336
    s_waitcnt lgkmcnt(7)
    v_mfma_f32_16x16x32_bf16 v[112:115], v[156:159], v[44:47], v[112:115]
    v_mfma_f32_16x16x32_bf16 v[116:119], v[220:223], v[44:47], v[116:119]
    ds_read_b128 v[44:47], v13 offset:15360
    s_waitcnt lgkmcnt(7)
    v_mfma_f32_16x16x32_bf16 v[112:115], v[160:163], v[16:19], v[112:115]
    v_mfma_f32_16x16x32_bf16 v[116:119], v[224:227], v[16:19], v[116:119]
    s_waitcnt lgkmcnt(6)
    v_mfma_f32_16x16x32_bf16 v[112:115], v[164:167], v[20:23], v[112:115]
    v_mfma_f32_16x16x32_bf16 v[116:119], v[228:231], v[20:23], v[116:119]
    s_waitcnt lgkmcnt(5)
    v_mfma_f32_16x16x32_bf16 v[112:115], v[168:171], v[24:27], v[112:115]
    v_mfma_f32_16x16x32_bf16 v[116:119], v[232:235], v[24:27], v[116:119]
    s_waitcnt lgkmcnt(4)
    v_mfma_f32_16x16x32_bf16 v[112:115], v[172:175], v[28:31], v[112:115]
    v_mfma_f32_16x16x32_bf16 v[116:119], v[236:239], v[28:31], v[116:119]
    s_waitcnt lgkmcnt(3)
    v_mfma_f32_16x16x32_bf16 v[112:115], v[176:179], v[32:35], v[112:115]
    v_mfma_f32_16x16x32_bf16 v[116:119], v[240:243], v[32:35], v[116:119]
    s_waitcnt lgkmcnt(2)
    v_mfma_f32_16x16x32_bf16 v[112:115], v[180:183], v[36:39], v[112:115]
    v_mfma_f32_16x16x32_bf16 v[116:119], v[244:247], v[36:39], v[116:119]
    s_waitcnt lgkmcnt(1)
    v_mfma_f32_16x16x32_bf16 v[112:115], v[184:187], v[40:43], v[112:115]
    v_mfma_f32_16x16x32_bf16 v[116:119], v[248:251], v[40:43], v[116:119]
    s_waitcnt lgkmcnt(0)
    v_mfma_f32_16x16x32_bf16 v[112:115], v[188:191], v[44:47], v[112:115]
    v_mfma_f32_16x16x32_bf16 v[116:119], v[252:255], v[44:47], v[116:119]
    s_nop 7
    v_bfi_b32 v112, s46, v5, v112
    v_bfi_b32 v113, s46, v5, v113
    v_bfi_b32 v114, s46, v5, v114
    v_bfi_b32 v115, s46, v5, v115
    v_bfi_b32 v116, s46, v5, v116
    v_bfi_b32 v117, s46, v5, v117
    v_bfi_b32 v118, s46, v5, v118
    v_bfi_b32 v119, s46, v5, v119
    buffer_store_dwordx4 v[112:115], v8, s[28:31], s45 offen offset:0 sc1
    buffer_store_dwordx4 v[116:119], v8, s[28:31], s45 offen offset:1024 sc1
    s_xor_b32 s63, s63, 1
    s_lshl_b32 s43, s63, 2
    v_add_u32 v12, s43, v3
L_msw2:
    ds_read_b32 v4, v12 offset:40
    s_waitcnt lgkmcnt(0)
    v_readfirstlane_b32 s43, v4
    s_cmp_ge_u32 s43, 4
    s_cbranch_scc1 L_msgo2
    s_sub_u32 s42, s42, 1
    s_cbranch_scc0 L_msw2
    s_endpgm
L_msgo2:
    s_lshl_b32 s43, s63, 14
    v_add_u32 v13, s43, v2
    ds_read_b128 v[16:19], v13 offset:0
    ds_read_b128 v[20:23], v13 offset:1024
    ds_read_b128 v[24:27], v13 offset:2048
    ds_read_b128 v[28:31], v13 offset:3072
    ds_read_b128 v[32:35], v13 offset:4096
    ds_read_b128 v[36:39], v13 offset:5120
    ds_read_b128 v[40:43], v13 offset:6144
    ds_read_b128 v[44:47], v13 offset:7168
    s_lshl_b32 s45, s63, 13
    s_add_u32 s45, s45, s44
    s_waitcnt lgkmcnt(7)
    v_mfma_f32_16x16x32_bf16 v[120:123], v[128:131], v[16:19], 0
    v_mfma_f32_16x16x32_bf16 v[124:127], v[192:195], v[16:19], 0
    ds_read_b128 v[16:19], v13 offset:8192
    s_waitcnt lgkmcnt(7)
    v_mfma_f32_16x16x32_bf16 v[120:123], v[132:135], v[20:23], v[120:123]
    v_mfma_f32_16x16x32_bf16 v[124:127], v[196:199], v[20:23], v[124:127]
    ds_read_b128 v[20:23], v13 offset:9216
    s_waitcnt lgkmcnt(7)
    v_mfma_f32_16x16x32_bf16 v[120:123], v[136:139], v[24:27], v[120:123]
    v_mfma_f32_16x16x32_bf16 v[124:127], v[200:203], v[24:27], v[124:127]
    ds_read_b128 v[24:27], v13 offset:10240
    s_waitcnt lgkmcnt(7)
    v_mfma_f32_16x16x32_bf16 v[120:123], v[140:143], v[28:31], v[120:123]
    v_mfma_f32_16x16x32_bf16 v[124:127], v[204:207], v[28:31], v[124:127]
    ds_read_b128 v[28:31], v13 offset:11264
    s_waitcnt lgkmcnt(7)
    v_mfma_f32_16x16x32_bf16 v[120:123], v[144:147], v[32:35], v[120:123]
    v_mfma_f32_16x16x32_bf16 v[124:127], v[208:211], v[32:35], v[124:127]
    ds_read_b128 v[32:35], v13 offset:12288
    s_waitcnt lgkmcnt(7)
    v_mfma_f32_16x16x32_bf16 v[120:123], v[148:151], v[36:39], v[120:123]
    v_mfma_f32_16x16x32_bf16 v[124:127], v[212:215], v[36:39], v[124:127]
    ds_read_b128 v[36:39], v13 offset:13312
    s_waitcnt lgkmcnt(7)
    v_mfma_f32_16x16x32_bf16 v[120:123], v[152:155], v[40:43], v[120:123]
    v_mfma_f32_16x16x32_bf16 v[124:127], v[216:219], v[40:43], v[124:127]
    ds_read_b128 v[40:43], v13 offset:14336
    s_waitcnt lgkmcnt(7)
    v_mfma_f32_16x16x32_bf16 v[120:123], v[156:159], v[44:47], v[120:123]
    v_mfma_f32_16x16x32_bf16 v[124:127], v[220:223], v[44:47], v[124:127]
    ds_read_b128 v[44:47], v13 offset:15360
    s_waitcnt lgkmcnt(7)
    v_mfma_f32_16x16x32_bf16 v[120:123], v[160:163], v[16:19], v[120:123]
    v_mfma_f32_16x16x32_bf16 v[124:127], v[224:227], v[16:19], v[124:127]
    s_waitcnt lgkmcnt(6)
    v_mfma_f32_16x16x32_bf16 v[120:123], v[164:167], v[20:23], v[120:123]
    v_mfma_f32_16x16x32_bf16 v[124:127], v[228:231], v[20:23], v[124:127]
    s_waitcnt lgkmcnt(5)
    v_mfma_f32_16x16x32_bf16 v[120:123], v[168:171], v[24:27], v[120:123]
    v_mfma_f32_16x16x32_bf16 v[124:127], v[232:235], v[24:27], v[124:127]
    s_waitcnt lgkmcnt(4)
    v_mfma_f32_16x16x32_bf16 v[120:123], v[172:175], v[28:31], v[120:123]
    v_mfma_f32_16x16x32_bf16 v[124:127], v[236:239], v[28:31], v[124:127]
    s_waitcnt lgkmcnt(3)
    v_mfma_f32_16x16x32_bf16 v[120:123], v[176:179], v[32:35], v[120:123]
    v_mfma_f32_16x16x32_bf16 v[124:127], v[240:243], v[32:35], v[124:127]
    s_waitcnt lgkmcnt(2)
    v_mfma_f32_16x16x32_bf16 v[120:123], v[180:183], v[36:39], v[120:123]
    v_mfma_f32_16x16x32_bf16 v[124:127], v[244:247], v[36:39], v[124:127]
    s_waitcnt lgkmcnt(1)
    v_mfma_f32_16x16x32_bf16 v[120:123], v[184:187], v[40:43], v[120:123]
    v_mfma_f32_16x16x32_bf16 v[124:127], v[248:251], v[40:43], v[124:127]
    s_waitcnt lgkmcnt(0)
    v_mfma_f32_16x16x32_bf16 v[120:123], v[188:191], v[44:47], v[120:123]
    v_mfma_f32_16x16x32_bf16 v[124:127], v[252:255], v[44:47], v[124:127]
    s_nop 7
    v_bfi_b32 v120, s46, v5, v120
    v_bfi_b32 v121, s46, v5, v121
    v_bfi_b32 v122, s46, v5, v122
    v_bfi_b32 v123, s46, v5, v123
    v_bfi_b32 v124, s46, v5, v124
    v_bfi_b32 v125, s46, v5, v125
    v_bfi_b32 v126, s46, v5, v126
    v_bfi_b32 v127, s46, v5, v127
    buffer_store_dwordx4 v[120:123], v8, s[28:31], s45 offen offset:0 sc1
    buffer_store_dwordx4 v[124:127], v8, s[28:31], s45 offen offset:1024 sc1
    s_mov_b64 exec, 1
    ds_add_u32 v3, v14 offset:32
    s_mov_b64 exec, -1
    s_branch L_done
L_reduce:
    s_cmp_lt_u32 s40, 6
    s_cbranch_scc1 L_done
    s_lshr_b32 s44, s48, 2
    s_lshl_b32 s44, s44, 13
    s_add_u32 s55, s55, s44
    s_and_b32 s44, s48, 3
    s_lshl_b32 s44, s44, 8
    s_add_u32 s55, s55, s44
    s_and_b32 s44, s40, 1
    s_lshl_b32 s45, s44, 12
    s_add_u32 s55, s55, s45
    v_lshrrev_b32 v6, 4, v1
    v_and_b32 v8, 0xff, v2
    v_lshl_add_u32 v8, v6, 10, v8
L_wf_99:
    ds_read_b32 v4, v3 offset:32
    s_waitcnt lgkmcnt(0)
    v_readfirstlane_b32 s43, v4
    s_cmp_ge_u32 s43, 4
    s_cbranch_scc1 L_wd_100
    s_sleep 1
    s_sub_u32 s42, s42, 1
    s_cbranch_scc0 L_wf_99
    s_endpgm
L_wd_100:
    s_sleep 4
L_ppoll:
    s_mov_b32 s45, s55
    buffer_load_dwordx4 v[16:19], v8, s[28:31], s45 offen sc1
    s_add_u32 s45, s45, 16384
    buffer_load_dwordx4 v[20:23], v8, s[28:31], s45 offen sc1
    s_add_u32 s45, s45, 16384
    buffer_load_dwordx4 v[24:27], v8, s[28:31], s45 offen sc1
    s_add_u32 s45, s45, 16384
    buffer_load_dwordx4 v[28:31], v8, s[28:31], s45 offen sc1
    s_add_u32 s45, s45, 16384
    buffer_load_dwordx4 v[32:35], v8, s[28:31], s45 offen sc1
    s_add_u32 s45, s45, 16384
    buffer_load_dwordx4 v[36:39], v8, s[28:31], s45 offen sc1
    s_add_u32 s45, s45, 16384
    buffer_load_dwordx4 v[40:43], v8, s[28:31], s45 offen sc1
    s_add_u32 s45, s45, 16384
    buffer_load_dwordx4 v[44:47], v8, s[28:31], s45 offen sc1
    s_waitcnt vmcnt(0)
    v_xor_b32 v4, v5, v16
    v_bitop3_b32 v4, v5, v17, v4 bitop3:0xbe
    v_bitop3_b32 v4, v5, v18, v4 bitop3:0xbe
    v_bitop3_b32 v4, v5, v19, v4 bitop3:0xbe
    v_bitop3_b32 v4, v5, v20, v4 bitop3:0xbe
    v_bitop3_b32 v4, v5, v21, v4 bitop3:0xbe
    v_bitop3_b32 v4, v5, v22, v4 bitop3:0xbe
    v_bitop3_b32 v4, v5, v23, v4 bitop3:0xbe
    v_bitop3_b32 v4, v5, v24, v4 bitop3:0xbe
    v_bitop3_b32 v4, v5, v25, v4 bitop3:0xbe
    v_bitop3_b32 v4, v5, v26, v4 bitop3:0xbe
    v_bitop3_b32 v4, v5, v27, v4 bitop3:0xbe
    v_bitop3_b32 v4, v5, v28, v4 bitop3:0xbe
    v_bitop3_b32 v4, v5, v29, v4 bitop3:0xbe
    v_bitop3_b32 v4, v5, v30, v4 bitop3:0xbe
    v_bitop3_b32 v4, v5, v31, v4 bitop3:0xbe
    v_bitop3_b32 v4, v5, v32, v4 bitop3:0xbe
    v_bitop3_b32 v4, v5, v33, v4 bitop3:0xbe
    v_bitop3_b32 v4, v5, v34, v4 bitop3:0xbe
    v_bitop3_b32 v4, v5, v35, v4 bitop3:0xbe
    v_bitop3_b32 v4, v5, v36, v4 bitop3:0xbe
    v_bitop3_b32 v4, v5, v37, v4 bitop3:0xbe
    v_bitop3_b32 v4, v5, v38, v4 bitop3:0xbe
    v_bitop3_b32 v4, v5, v39, v4 bitop3:0xbe
    v_bitop3_b32 v4, v5, v40, v4 bitop3:0xbe
    v_bitop3_b32 v4, v5, v41, v4 bitop3:0xbe
    v_bitop3_b32 v4, v5, v42, v4 bitop3:0xbe
    v_bitop3_b32 v4, v5, v43, v4 bitop3:0xbe
    v_bitop3_b32 v4, v5, v44, v4 bitop3:0xbe
    v_bitop3_b32 v4, v5, v45, v4 bitop3:0xbe
    v_bitop3_b32 v4, v5, v46, v4 bitop3:0xbe
    v_bitop3_b32 v4, v5, v47, v4 bitop3:0xbe
    v_and_b32 v4, s46, v4
    v_cmp_ne_u32 vcc, 0, v4
    s_cbranch_vccz L_pok
    s_sleep 1
    s_sub_u32 s42, s42, 1
    s_cbranch_scc0 L_ppoll
    s_endpgm
L_pok:
    s_mov_b32 s46, 0xffffff00
    v_and_b32 v16, s46, v16
    v_and_b32 v17, s46, v17
    v_and_b32 v18, s46, v18
    v_and_b32 v19, s46, v19
    v_and_b32 v20, s46, v20
    v_and_b32 v21, s46, v21
    v_and_b32 v22, s46, v22
    v_and_b32 v23, s46, v23
    v_and_b32 v24, s46, v24
    v_and_b32 v25, s46, v25
    v_and_b32 v26, s46, v26
    v_and_b32 v27, s46, v27
    v_and_b32 v28, s46, v28
    v_and_b32 v29, s46, v29
    v_and_b32 v30, s46, v30
    v_and_b32 v31, s46, v31
    v_and_b32 v32, s46, v32
    v_and_b32 v33, s46, v33
    v_and_b32 v34, s46, v34
    v_and_b32 v35, s46, v35
    v_and_b32 v36, s46, v36
    v_and_b32 v37, s46, v37
    v_and_b32 v38, s46, v38
    v_and_b32 v39, s46, v39
    v_and_b32 v40, s46, v40
    v_and_b32 v41, s46, v41
    v_and_b32 v42, s46, v42
    v_and_b32 v43, s46, v43
    v_and_b32 v44, s46, v44
    v_and_b32 v45, s46, v45
    v_and_b32 v46, s46, v46
    v_and_b32 v47, s46, v47
    v_add_f32 v16, v16, v20
    v_add_f32 v17, v17, v21
    v_add_f32 v18, v18, v22
    v_add_f32 v19, v19, v23
    v_add_f32 v16, v16, v24
    v_add_f32 v17, v17, v25
    v_add_f32 v18, v18, v26
    v_add_f32 v19, v19, v27
    v_add_f32 v16, v16, v28
    v_add_f32 v17, v17, v29
    v_add_f32 v18, v18, v30
    v_add_f32 v19, v19, v31
    v_add_f32 v16, v16, v32
    v_add_f32 v17, v17, v33
    v_add_f32 v18, v18, v34
    v_add_f32 v19, v19, v35
    v_add_f32 v16, v16, v36
    v_add_f32 v17, v17, v37
    v_add_f32 v18, v18, v38
    v_add_f32 v19, v19, v39
    v_add_f32 v16, v16, v40
    v_add_f32 v17, v17, v41
    v_add_f32 v18, v18, v42
    v_add_f32 v19, v19, v43
    v_add_f32 v16, v16, v44
    v_add_f32 v17, v17, v45
    v_add_f32 v18, v18, v46
    v_add_f32 v19, v19, v47
    v_cvt_pk_bf16_f32 v16, v16, v17
    v_cvt_pk_bf16_f32 v17, v18, v19
    v_and_b32 v4, 3, v1
    v_lshrrev_b32 v6, 2, v1
    v_lshlrev_b32 v6, 3, v6
    v_lshl_add_u32 v4, v4, 11, v6
    s_and_b32 s45, s49, 24
    s_add_u32 s45, s45, s48
    s_lshl_b32 s45, s45, 13
    s_and_b32 s46, s49, 7
    s_lshl_b32 s46, s46, 8
    s_add_u32 s45, s45, s46
    s_lshl_b32 s44, s44, 7
    s_add_u32 s45, s45, s44
    buffer_store_dwordx2 v[16:17], v4, s[36:39], s45 offen sc1
L_done:
L_exit:
    s_endpgm
.fill 256, 4, 0xbf800000
.section .rodata,"a"
.p2align 6
.amdhsa_kernel standalone__gqa_block_cached__sampling_kernel
  .amdhsa_next_free_vgpr 256
  .amdhsa_next_free_sgpr 102
  .amdhsa_accum_offset 256
  .amdhsa_group_segment_fixed_size 0
  .amdhsa_kernarg_size 64
  .amdhsa_user_sgpr_count 2
  .amdhsa_user_sgpr_kernarg_segment_ptr 1
  .amdhsa_system_sgpr_workgroup_id_x 1
  .amdhsa_float_denorm_mode_32 3
  .amdhsa_float_denorm_mode_16_64 3
.end_amdhsa_kernel
```
